```python
import torch

def _softmax(x, axis=-1):
    return torch.softmax(x, dim=axis)
def _gelu(x):
    return torch.nn.functional.gelu(x, approximate="tanh")
def _silu(x):
    return torch.nn.functional.silu(x)
def _sigmoid(x):
    return torch.sigmoid(x)
def _layernorm(x, axis=-1, eps=1e-5):
    m = x.mean(dim=axis, keepdim=True)
    v = x.var(dim=axis, keepdim=True, unbiased=False)
    return (x - m) / torch.sqrt(v + eps)
def _scatter_add(tgt, idx, src, axis=0):
    return tgt.clone().index_add_(axis, idx, src)
def _segment_sum(src, seg, n):
    out = torch.zeros((n,) + src.shape[1:], dtype=src.dtype)
    return out.index_add_(0, seg, src)
def _pad(x, pw):
    flat = tuple(v for pair in reversed(pw) for v in pair)
    return torch.nn.functional.pad(x, flat)

kernel_name = 'standalone__gqa_softmax__near_ridge'

def setup_inputs():

    _w = (lambda a: (lambda t: t.to(torch.bfloat16) if t.is_floating_point() else t)(torch.as_tensor(a)))
    B, Hq, Hkv, Sq, Sk, D = 8, 32, 8, 128, 512, 128
    return {
        "q": _w((lambda *s: torch.randn(*s, dtype=torch.bfloat16) * 0.8)(B, Hq, Sq, D)),
        "k": _w((lambda *s: torch.randn(*s, dtype=torch.bfloat16) * 0.8)(B, Hkv, Sk, D)),
        "v": _w((lambda *s: torch.randn(*s, dtype=torch.bfloat16) * 0.05)(B, Hkv, Sk, D)),
    }

def reference(q, k, v):
    B, Hq, Sq, D = q.shape
    Hkv = k.shape[1]
    rep = Hq // Hkv
    k = (lambda x, n, axis: torch.repeat_interleave(x, n, dim=axis))(k, rep, axis=1)
    v = (lambda x, n, axis: torch.repeat_interleave(x, n, dim=axis))(v, rep, axis=1)
    scale = D ** -0.5
    scores = torch.einsum("bhqd,bhkd->bhqk", q, k) * scale
    p = _softmax(scores, axis=-1)
    return torch.einsum("bhqk,bhkd->bhqd", p, v)
```

```asm
; @launch grid=(256,1,1) block=(384,1,1) lds=133632
.amdgcn_target "amdgcn-amd-amdhsa--gfx950"
.text
.globl standalone__gqa_softmax__near_ridge_kernel
.p2align 12
.p2align 8
.type standalone__gqa_softmax__near_ridge_kernel,@function
standalone__gqa_softmax__near_ridge_kernel:
    s_load_dwordx2 s[8:9], s[0:1], 0
    s_load_dwordx2 s[12:13], s[0:1], 8
    s_load_dwordx2 s[16:17], s[0:1], 16
    s_load_dwordx2 s[20:21], s[0:1], 24
    s_cmp_ge_u32 s2, 256
    s_cbranch_scc1 L_end
    v_readfirstlane_b32 s3, v0
    v_and_b32 v2, 63, v0
    s_and_b32 s35, s2, 7
    s_lshr_b32 s36, s2, 5
    s_lshl_b32 s36, s36, 3
    s_add_u32 s35, s35, s36
    s_bfe_u32 s37, s2, 0x20003
    s_lshl_b32 s29, s35, 17
    s_lshl_b32 s28, s37, 15
    s_add_u32 s28, s28, s29
    s_lshr_b32 s3, s3, 6
    s_mov_b32 s30, 0
    s_mov_b32 s10, 0x800000
    s_mov_b32 s11, 0x20000
    s_mov_b64 s[14:15], s[10:11]
    s_mov_b64 s[18:19], s[10:11]
    s_mov_b64 s[22:23], s[10:11]
    v_lshrrev_b32 v3, 3, v2
    v_and_b32 v4, 7, v2
    s_lshl_b32 s33, s3, 13
    s_add_u32 s35, s33, s28
    s_add_u32 s34, s35, 4096
    s_cmp_ge_u32 s3, 4
    s_cbranch_scc1 L_loader
L_top_c:
    v_lshlrev_b32 v1, 8, v3
    v_lshl_or_b32 v1, v4, 4, v1
    v_and_b32 v248, 0x70, v0
    v_xor_b32 v248, v248, v1
    s_lshl_b32 s27, s3, 10
    s_lshl_b32 s24, s3, 11
    s_add_u32 s24, s24, s29
    v_or_b32 v248, s24, v248
    s_mov_b32 s26, 0x2000
    s_mov_b32 s32, 0x4000
    s_mov_b32 m0, s27
    s_waitcnt lgkmcnt(0)
    s_and_b32 s13, s13, 0xffff
    s_and_b32 s9, s9, 0xffff
    buffer_load_dwordx4 v248, s[12:15], 0 offen lds
    buffer_load_dwordx4 v[208:211], v1, s[8:11], s35 offen offset:0
    buffer_load_dwordx4 v[212:215], v1, s[8:11], s35 offen offset:2048
    buffer_load_dwordx4 v[216:219], v1, s[8:11], s34 offen offset:0
    s_add_u32 m0, s27, 8192
    buffer_load_dwordx4 v[220:223], v1, s[8:11], s34 offen offset:2048
    buffer_load_dwordx4 v248, s[12:15], s26 offen lds
    s_branch L_cback
L_loader:
    s_mov_b64 exec, 0
    s_cmp_eq_u32 s3, 4
    s_cbranch_scc1 L_pad68
    s_branch L_pad182
L_lback:
    s_mov_b64 exec, -1
    s_and_b32 s3, s3, 1
    s_lshl_b32 s33, s3, 11
    s_lshl_b32 s36, s3, 12
    s_add_u32 s36, s36, s29
    v_lshlrev_b32 v5, 8, v3
    v_add_u32 v5, s36, v5
    v_lshrrev_b32 v6, 1, v3
    v_xor_b32 v7, v6, v4
    v_lshl_or_b32 v10, v7, 4, v5
    v_xor_b32 v11, 0x840, v10
    v_and_b32 v6, 1, v6
    v_lshlrev_b32 v6, 2, v6
    v_xor_b32 v7, v6, v4
    v_lshl_or_b32 v8, v7, 4, v5
    v_xor_b32 v9, 0x800, v8
    v_mov_b32 v13, 133120
    v_mov_b32 v14, 0
    ds_write_b32 v13, v14
    s_getpc_b64 s[4:5]
L_pc:
    s_add_u32 s6, s4, L_subV-L_pc
    s_addc_u32 s7, s5, 0
    s_add_u32 s24, s4, L_subKb-L_pc
    s_addc_u32 s25, s5, 0
    s_add_u32 s4, s4, L_subKa-L_pc
    s_addc_u32 s5, s5, 0
    s_waitcnt lgkmcnt(0)
    s_and_b32 s13, s13, 0xffff
    s_and_b32 s17, s17, 0xffff
L_top_l:
    s_mov_b32 s35, 65536
    s_mov_b32 s37, 0
    s_mov_b32 s34, 0
    s_branch L_ld2
L_subKa:
    s_and_b32 s38, s35, 0xffff
    s_add_u32 s38, s38, s33
    s_mov_b32 m0, s38
    s_nop 0
    buffer_load_dwordx4 v10, s[12:15], s35 offen lds
    s_add_u32 m0, s38, 1024
    s_nop 0
    buffer_load_dwordx4 v11, s[12:15], s35 offen lds
    s_add_u32 s35, s35, 8192
    s_setpc_b64 s[40:41]
L_subKb:
    s_and_b32 s38, s37, 0xffff
    s_add_u32 s38, s38, s33
    s_add_u32 m0, s38, 3968
    s_nop 0
    buffer_load_dwordx4 v10, s[12:15], s37 offen offset:128 lds
    s_add_u32 m0, s38, 4992
    s_nop 0
    buffer_load_dwordx4 v11, s[12:15], s37 offen offset:128 lds
    s_add_u32 s37, s37, 8192
    s_setpc_b64 s[40:41]
L_subV:
    s_and_b32 s38, s34, 0xffff
    s_add_u32 s38, s38, s33
    s_add_u32 m0, s38, 65536
    s_nop 0
    buffer_load_dwordx4 v8, s[16:19], s34 offen lds
    s_add_u32 m0, s38, 66560
    s_nop 0
    buffer_load_dwordx4 v9, s[16:19], s34 offen lds
    s_add_u32 m0, s38, 69504
    s_nop 0
    buffer_load_dwordx4 v8, s[16:19], s34 offen offset:128 lds
    s_add_u32 m0, s38, 70528
    s_nop 0
    buffer_load_dwordx4 v9, s[16:19], s34 offen offset:128 lds
    s_add_u32 s34, s34, 8192
    s_setpc_b64 s[40:41]
L_ld2:
    s_barrier
    s_barrier
    s_swappc_b64 s[40:41], s[24:25]
    s_swappc_b64 s[40:41], s[24:25]
    s_swappc_b64 s[40:41], s[24:25]
    s_swappc_b64 s[40:41], s[24:25]
    s_barrier
    s_swappc_b64 s[40:41], s[24:25]
    s_swappc_b64 s[40:41], s[24:25]
    s_swappc_b64 s[40:41], s[24:25]
    s_swappc_b64 s[40:41], s[24:25]
    s_waitcnt vmcnt(8)
    s_barrier
    s_swappc_b64 s[40:41], s[6:7]
    s_swappc_b64 s[40:41], s[6:7]
    s_waitcnt vmcnt(8)
    s_barrier
    s_swappc_b64 s[40:41], s[6:7]
    s_swappc_b64 s[40:41], s[6:7]
    s_waitcnt vmcnt(8)
    s_barrier
    s_swappc_b64 s[40:41], s[6:7]
    s_swappc_b64 s[40:41], s[4:5]
    s_swappc_b64 s[40:41], s[24:25]
    s_waitcnt vmcnt(8)
    s_barrier
    s_swappc_b64 s[40:41], s[6:7]
    s_swappc_b64 s[40:41], s[4:5]
    s_swappc_b64 s[40:41], s[24:25]
    s_swappc_b64 s[40:41], s[6:7]
    s_swappc_b64 s[40:41], s[4:5]
    s_swappc_b64 s[40:41], s[24:25]
    s_waitcnt vmcnt(16)
    s_barrier
    s_swappc_b64 s[40:41], s[6:7]
    s_swappc_b64 s[40:41], s[4:5]
    s_swappc_b64 s[40:41], s[24:25]
    s_waitcnt vmcnt(16)
    s_barrier
    s_swappc_b64 s[40:41], s[6:7]
    s_swappc_b64 s[40:41], s[4:5]
    s_swappc_b64 s[40:41], s[24:25]
    s_swappc_b64 s[40:41], s[6:7]
    s_waitcnt vmcnt(20)
    s_barrier
    s_swappc_b64 s[40:41], s[4:5]
    s_swappc_b64 s[40:41], s[24:25]
    s_swappc_b64 s[40:41], s[6:7]
    s_swappc_b64 s[40:41], s[4:5]
    s_swappc_b64 s[40:41], s[24:25]
    s_waitcnt vmcnt(24)
    s_barrier
    s_and_b32 s21, s21, 0xffff
    buffer_load_dword v20, off, s[20:23], s28
    s_swappc_b64 s[40:41], s[6:7]
    s_swappc_b64 s[40:41], s[4:5]
    s_swappc_b64 s[40:41], s[24:25]
    s_swappc_b64 s[40:41], s[6:7]
    s_waitcnt vmcnt(29)
    s_barrier
    s_swappc_b64 s[40:41], s[6:7]
    s_swappc_b64 s[40:41], s[6:7]
    s_waitcnt vmcnt(29)
    s_barrier
    s_swappc_b64 s[40:41], s[6:7]
    s_waitcnt vmcnt(24)
    s_barrier
    s_waitcnt vmcnt(16)
    s_barrier
    s_waitcnt vmcnt(0)
    s_barrier
L_lend:
    s_cmp_lg_u32 s30, 0
    s_cbranch_scc1 L_end
    s_barrier
    ds_read_b32 v14, v13
    s_waitcnt lgkmcnt(0)
    v_readfirstlane_b32 s36, v14
    s_nop 3
    s_cmp_eq_u32 s36, 0
    s_cbranch_scc1 L_end
    s_mov_b32 s30, 1
    s_branch L_top_l
L_cback:
    v_and_b32 v240, 63, v0
    v_and_b32 v251, 31, v240
    v_lshrrev_b32 v252, 5, v240
    s_and_b32 s21, s21, 0xffff
    s_mov_b32 s42, 0x35800000
    s_mov_b32 s43, 0x49800000
    s_mov_b32 s40, 0x3e0293ee
    s_mov_b32 s41, 0x3e0293ee
    s_mov_b32 s39, 0xffff0000
    s_mul_i32 s38, s3, 8704
    s_add_u32 s38, s38, 98304
    s_mul_i32 s25, s3, 10240
    s_add_u32 s25, s25, 0
    v_and_b32 v241, 7, v240
    v_lshrrev_b32 v242, 3, v240
    v_mul_u32_u24 v12, 544, v241
    v_lshl_add_u32 v12, v242, 4, v12
    v_add_u32 v12, s38, v12
    v_mul_u32_u24 v13, 544, v252
    v_lshl_add_u32 v13, v251, 4, v13
    v_add_u32 v13, s38, v13
    s_add_u32 m0, s27, s32
    s_nop 0
    buffer_load_dwordx4 v248, s[12:15], s32 offen lds
    s_add_u32 s32, s32, s26
    s_add_u32 m0, s27, s32
    s_nop 0
    buffer_load_dwordx4 v248, s[12:15], s32 offen lds
    s_add_u32 s32, s32, s26
    s_add_u32 m0, s27, s32
    s_nop 0
    buffer_load_dwordx4 v248, s[12:15], s32 offen lds
    s_add_u32 s32, s32, s26
    s_add_u32 m0, s27, s32
    s_nop 0
    buffer_load_dwordx4 v248, s[12:15], s32 offen lds
    s_add_u32 s32, s32, s26
    s_add_u32 m0, s27, s32
    s_nop 0
    buffer_load_dwordx4 v248, s[12:15], s32 offen lds
    s_add_u32 s32, s32, s26
    s_add_u32 m0, s27, s32
    s_nop 0
    buffer_load_dwordx4 v248, s[12:15], s32 offen lds
    s_add_u32 s32, s32, s26
    v_lshrrev_b32 v243, 3, v251
    v_lshlrev_b32 v243, 10, v243
    v_and_b32 v244, 7, v251
    v_lshl_or_b32 v243, v244, 7, v243
    v_bfe_u32 v244, v251, 1, 3
    v_xor_b32 v245, v244, v252
    v_lshl_or_b32 v4, v245, 4, v243
    v_xor_b32 v5, 32, v4
    v_xor_b32 v6, 64, v4
    v_xor_b32 v7, 96, v4
    v_bfe_u32 v243, v240, 2, 2
    v_lshl_or_b32 v243, v252, 2, v243
    v_bfe_u32 v245, v243, 1, 1
    v_lshlrev_b32 v243, 7, v243
    v_bfe_u32 v246, v240, 4, 1
    v_lshl_or_b32 v243, v246, 5, v243
    v_and_b32 v246, 3, v240
    v_lshl_or_b32 v243, v246, 3, v243
    v_or_b32 v243, 0x10000, v243
    v_lshl_or_b32 v2, v245, 6, v243
    v_xor_b32 v3, 64, v2
    v_lshrrev_b32 v243, 2, v240
    v_lshrrev_b32 v244, 4, v240
    v_xor_b32 v243, v243, v244
    v_and_b32 v243, 1, v243
    v_add_u32 v243, -1, v243
    v_and_b32 v8, 0x3f803f80, v243
    v_and_b32 v9, 0x3f803f80, v243
    v_and_b32 v10, 0x3f803f80, v243
    v_and_b32 v11, 0x3f803f80, v243
    s_cmp_lg_u32 s30, 0
    s_cbranch_scc1 L_nomz
    v_mov_b32 v16, 0
    v_mov_b32 v17, 0
    v_mov_b32 v18, 0
    v_mov_b32 v19, 0
    v_mov_b32 v20, 0
    v_mov_b32 v21, 0
    v_mov_b32 v22, 0
    v_mov_b32 v23, 0
    v_mov_b32 v24, 0
    v_mov_b32 v25, 0
    v_mov_b32 v26, 0
    v_mov_b32 v27, 0
    v_mov_b32 v28, 0
    v_mov_b32 v29, 0
    v_mov_b32 v30, 0
    v_mov_b32 v31, 0
L_nomz:
L_cand0:
    s_waitcnt vmcnt(10)
    v_lshlrev_b32 v160, 16, v208
    v_and_b32 v161, s39, v208
    v_lshlrev_b32 v162, 16, v209
    v_and_b32 v163, s39, v209
    v_lshlrev_b32 v164, 16, v210
    v_and_b32 v165, s39, v210
    v_lshlrev_b32 v166, 16, v211
    v_and_b32 v167, s39, v211
    v_pk_mul_f32 v[160:161], v[160:161], s[40:41]
    v_pk_mul_f32 v[162:163], v[162:163], s[40:41]
    v_pk_mul_f32 v[164:165], v[164:165], s[40:41]
    v_pk_mul_f32 v[166:167], v[166:167], s[40:41]
    v_cvt_pk_bf16_f32 v208, v160, v161
    v_cvt_pk_bf16_f32 v209, v162, v163
    v_cvt_pk_bf16_f32 v210, v164, v165
    v_cvt_pk_bf16_f32 v211, v166, v167
    ds_write_b128 v12, v[208:211] offset:0
    buffer_load_dwordx4 v[224:227], v1, s[8:11], s35 offen offset:128 nt
L_cand1:
    s_waitcnt vmcnt(10)
    v_lshlrev_b32 v168, 16, v212
    v_and_b32 v169, s39, v212
    v_lshlrev_b32 v170, 16, v213
    v_and_b32 v171, s39, v213
    v_lshlrev_b32 v172, 16, v214
    v_and_b32 v173, s39, v214
    v_lshlrev_b32 v174, 16, v215
    v_and_b32 v175, s39, v215
    v_pk_mul_f32 v[168:169], v[168:169], s[40:41]
    v_pk_mul_f32 v[170:171], v[170:171], s[40:41]
    v_pk_mul_f32 v[172:173], v[172:173], s[40:41]
    v_pk_mul_f32 v[174:175], v[174:175], s[40:41]
    v_cvt_pk_bf16_f32 v212, v168, v169
    v_cvt_pk_bf16_f32 v213, v170, v171
    v_cvt_pk_bf16_f32 v214, v172, v173
    v_cvt_pk_bf16_f32 v215, v174, v175
    ds_write_b128 v12, v[212:215] offset:128
    buffer_load_dwordx4 v[228:231], v1, s[8:11], s35 offen offset:2176 nt
L_cand2:
    s_waitcnt vmcnt(10)
    v_lshlrev_b32 v160, 16, v216
    v_and_b32 v161, s39, v216
    v_lshlrev_b32 v162, 16, v217
    v_and_b32 v163, s39, v217
    v_lshlrev_b32 v164, 16, v218
    v_and_b32 v165, s39, v218
    v_lshlrev_b32 v166, 16, v219
    v_and_b32 v167, s39, v219
    v_pk_mul_f32 v[160:161], v[160:161], s[40:41]
    v_pk_mul_f32 v[162:163], v[162:163], s[40:41]
    v_pk_mul_f32 v[164:165], v[164:165], s[40:41]
    v_pk_mul_f32 v[166:167], v[166:167], s[40:41]
    v_cvt_pk_bf16_f32 v216, v160, v161
    v_cvt_pk_bf16_f32 v217, v162, v163
    v_cvt_pk_bf16_f32 v218, v164, v165
    v_cvt_pk_bf16_f32 v219, v166, v167
    ds_write_b128 v12, v[216:219] offset:256
    buffer_load_dwordx4 v[232:235], v1, s[8:11], s34 offen offset:128 nt
L_cand3:
    s_waitcnt vmcnt(10)
    v_lshlrev_b32 v168, 16, v220
    v_and_b32 v169, s39, v220
    v_lshlrev_b32 v170, 16, v221
    v_and_b32 v171, s39, v221
    v_lshlrev_b32 v172, 16, v222
    v_and_b32 v173, s39, v222
    v_lshlrev_b32 v174, 16, v223
    v_and_b32 v175, s39, v223
    v_pk_mul_f32 v[168:169], v[168:169], s[40:41]
    v_pk_mul_f32 v[170:171], v[170:171], s[40:41]
    v_pk_mul_f32 v[172:173], v[172:173], s[40:41]
    v_pk_mul_f32 v[174:175], v[174:175], s[40:41]
    v_cvt_pk_bf16_f32 v220, v168, v169
    v_cvt_pk_bf16_f32 v221, v170, v171
    v_cvt_pk_bf16_f32 v222, v172, v173
    v_cvt_pk_bf16_f32 v223, v174, v175
    ds_write_b128 v12, v[220:223] offset:384
    buffer_load_dwordx4 v[236:239], v1, s[8:11], s34 offen offset:2176 nt
L_cand4:
    ds_read_b128 v[32:35], v13 offset:0
    ds_read_b128 v[36:39], v13 offset:1088
    ds_read_b128 v[40:43], v13 offset:2176
    ds_read_b128 v[44:47], v13 offset:3264
    s_waitcnt vmcnt(10)
    s_barrier
    ds_read_b128 v[176:179], v4 offset:0
    ds_read_b128 v[180:183], v5 offset:0
    ds_read_b128 v[184:187], v6 offset:0
    ds_read_b128 v[188:191], v7 offset:0
    ds_read_b128 v[192:195], v4 offset:8192
    ds_read_b128 v[196:199], v5 offset:8192
    ds_read_b128 v[200:203], v6 offset:8192
    ds_read_b128 v[204:207], v7 offset:8192
L_cand5:
    s_waitcnt lgkmcnt(7)
    v_mfma_f32_32x32x16_bf16 v[64:79], v[176:179], v[32:35], v[16:31]
L_cand6:
    s_waitcnt lgkmcnt(6)
    v_mfma_f32_32x32x16_bf16 v[64:79], v[180:183], v[36:39], v[64:79]
L_cand7:
    s_waitcnt lgkmcnt(5)
    v_mfma_f32_32x32x16_bf16 v[64:79], v[184:187], v[40:43], v[64:79]
L_cand8:
    s_waitcnt lgkmcnt(4)
    v_mfma_f32_32x32x16_bf16 v[64:79], v[188:191], v[44:47], v[64:79]
L_cand9:
    s_waitcnt lgkmcnt(3)
    v_mfma_f32_32x32x16_bf16 v[80:95], v[192:195], v[32:35], v[16:31]
L_cand10:
    s_waitcnt lgkmcnt(2)
    v_mfma_f32_32x32x16_bf16 v[80:95], v[196:199], v[36:39], v[80:95]
L_cand11:
    s_waitcnt lgkmcnt(1)
    v_mfma_f32_32x32x16_bf16 v[80:95], v[200:203], v[40:43], v[80:95]
L_cand12:
    s_waitcnt lgkmcnt(0)
    v_mfma_f32_32x32x16_bf16 v[80:95], v[204:207], v[44:47], v[80:95]
L_cand13:
    s_waitcnt vmcnt(7)
    s_barrier
    ds_read_b128 v[176:179], v4 offset:16384
    ds_read_b128 v[180:183], v5 offset:16384
    ds_read_b128 v[184:187], v6 offset:16384
    ds_read_b128 v[188:191], v7 offset:16384
    ds_read_b128 v[192:195], v4 offset:24576
    ds_read_b128 v[196:199], v5 offset:24576
    ds_read_b128 v[200:203], v6 offset:24576
    ds_read_b128 v[204:207], v7 offset:24576
    s_waitcnt lgkmcnt(7)
    v_mfma_f32_32x32x16_bf16 v[96:111], v[176:179], v[32:35], v[16:31]
L_cand14:
    ds_read_b128 v[176:179], v4 offset:32768
    s_waitcnt lgkmcnt(7)
    v_mfma_f32_32x32x16_bf16 v[96:111], v[180:183], v[36:39], v[96:111]
L_cand15:
    ds_read_b128 v[180:183], v5 offset:32768
    s_waitcnt lgkmcnt(7)
    v_mfma_f32_32x32x16_bf16 v[96:111], v[184:187], v[40:43], v[96:111]
L_cand16:
    ds_read_b128 v[184:187], v6 offset:32768
    s_waitcnt lgkmcnt(7)
    v_mfma_f32_32x32x16_bf16 v[96:111], v[188:191], v[44:47], v[96:111]
L_cand17:
    ds_read_b128 v[188:191], v7 offset:32768
    s_waitcnt lgkmcnt(7)
    v_mfma_f32_32x32x16_bf16 v[112:127], v[192:195], v[32:35], v[16:31]
L_cand18:
    s_waitcnt lgkmcnt(6)
    v_mfma_f32_32x32x16_bf16 v[112:127], v[196:199], v[36:39], v[112:127]
L_cand19:
    s_waitcnt lgkmcnt(5)
    v_mfma_f32_32x32x16_bf16 v[112:127], v[200:203], v[40:43], v[112:127]
L_cand20:
    s_waitcnt lgkmcnt(4)
    v_mfma_f32_32x32x16_bf16 v[112:127], v[204:207], v[44:47], v[112:127]
L_cand21:
    s_waitcnt lgkmcnt(3)
    v_mfma_f32_32x32x16_bf16 v[128:143], v[176:179], v[32:35], v[16:31]
L_cand22:
    s_waitcnt lgkmcnt(2)
    v_mfma_f32_32x32x16_bf16 v[128:143], v[180:183], v[36:39], v[128:143]
L_cand23:
    s_waitcnt lgkmcnt(1)
    v_mfma_f32_32x32x16_bf16 v[128:143], v[184:187], v[40:43], v[128:143]
L_cand24:
    s_waitcnt lgkmcnt(0)
    v_mfma_f32_32x32x16_bf16 v[128:143], v[188:191], v[44:47], v[128:143]
L_cand25:
    s_waitcnt vmcnt(4)
    s_barrier
    ds_read_b128 v[192:195], v4 offset:40960
    ds_read_b128 v[196:199], v5 offset:40960
    ds_read_b128 v[200:203], v6 offset:40960
    ds_read_b128 v[204:207], v7 offset:40960
    ds_read_b128 v[176:179], v4 offset:49152
    ds_read_b128 v[180:183], v5 offset:49152
    ds_read_b128 v[184:187], v6 offset:49152
    ds_read_b128 v[188:191], v7 offset:49152
    s_waitcnt lgkmcnt(7)
    v_mfma_f32_32x32x16_bf16 v[144:159], v[192:195], v[32:35], v[16:31]
L_cand26:
    ds_read_b128 v[192:195], v4 offset:57344
    s_waitcnt lgkmcnt(7)
    v_mfma_f32_32x32x16_bf16 v[144:159], v[196:199], v[36:39], v[144:159]
L_cand27:
    ds_read_b128 v[196:199], v5 offset:57344
    s_waitcnt vmcnt(3)
    v_lshlrev_b32 v208, 16, v224
    v_and_b32 v209, s39, v224
    v_lshlrev_b32 v210, 16, v225
    v_and_b32 v211, s39, v225
    v_lshlrev_b32 v212, 16, v226
    s_waitcnt lgkmcnt(7)
    v_mfma_f32_32x32x16_bf16 v[144:159], v[200:203], v[40:43], v[144:159]
L_cand28:
    ds_read_b128 v[200:203], v6 offset:57344
    v_and_b32 v213, s39, v226
    v_lshlrev_b32 v214, 16, v227
    v_and_b32 v215, s39, v227
    v_mul_f32 v208, s40, v208
    v_mul_f32 v209, s40, v209
    s_waitcnt lgkmcnt(7)
    v_mfma_f32_32x32x16_bf16 v[144:159], v[204:207], v[44:47], v[144:159]
L_cand29:
    ds_read_b128 v[204:207], v7 offset:57344
    v_mul_f32 v210, s40, v210
    v_mul_f32 v211, s40, v211
    v_mul_f32 v212, s40, v212
    v_mul_f32 v213, s40, v213
    v_mul_f32 v214, s40, v214
    s_waitcnt lgkmcnt(7)
    v_mfma_f32_32x32x16_bf16 v[160:175], v[176:179], v[32:35], v[16:31]
L_cand30:
    v_mul_f32 v215, s40, v215
    v_cvt_pk_bf16_f32 v224, v208, v209
    v_cvt_pk_bf16_f32 v225, v210, v211
    v_cvt_pk_bf16_f32 v226, v212, v213
    v_cvt_pk_bf16_f32 v227, v214, v215
    ds_write_b128 v12, v[224:227] offset:4352
L_cand31:
    s_waitcnt vmcnt(2)
    v_lshlrev_b32 v216, 16, v228
    v_and_b32 v217, s39, v228
    v_lshlrev_b32 v218, 16, v229
    v_and_b32 v219, s39, v229
    v_lshlrev_b32 v220, 16, v230
    s_waitcnt lgkmcnt(7)
    v_mfma_f32_32x32x16_bf16 v[160:175], v[180:183], v[36:39], v[160:175]
L_cand32:
    v_and_b32 v221, s39, v230
    v_lshlrev_b32 v222, 16, v231
    v_and_b32 v223, s39, v231
    v_mul_f32 v216, s40, v216
    v_mul_f32 v217, s40, v217
    s_waitcnt lgkmcnt(6)
    v_mfma_f32_32x32x16_bf16 v[160:175], v[184:187], v[40:43], v[160:175]
L_cand33:
    v_mul_f32 v218, s40, v218
    v_mul_f32 v219, s40, v219
    v_mul_f32 v220, s40, v220
    v_mul_f32 v221, s40, v221
    v_mul_f32 v222, s40, v222
    s_waitcnt lgkmcnt(5)
    v_mfma_f32_32x32x16_bf16 v[160:175], v[188:191], v[44:47], v[160:175]
L_cand34:
    v_mul_f32 v223, s40, v223
    v_cvt_pk_bf16_f32 v228, v216, v217
    v_cvt_pk_bf16_f32 v229, v218, v219
    v_cvt_pk_bf16_f32 v230, v220, v221
    v_cvt_pk_bf16_f32 v231, v222, v223
    ds_write_b128 v12, v[228:231] offset:4480
L_cand35:
    s_waitcnt vmcnt(1)
    v_lshlrev_b32 v208, 16, v232
    v_and_b32 v209, s39, v232
    v_lshlrev_b32 v210, 16, v233
    v_and_b32 v211, s39, v233
    v_lshlrev_b32 v212, 16, v234
    v_and_b32 v213, s39, v234
    v_lshlrev_b32 v214, 16, v235
    v_and_b32 v215, s39, v235
    v_pk_mul_f32 v[208:209], v[208:209], s[40:41]
    v_pk_mul_f32 v[210:211], v[210:211], s[40:41]
    v_pk_mul_f32 v[212:213], v[212:213], s[40:41]
    v_pk_mul_f32 v[214:215], v[214:215], s[40:41]
    v_cvt_pk_bf16_f32 v232, v208, v209
    v_cvt_pk_bf16_f32 v233, v210, v211
    v_cvt_pk_bf16_f32 v234, v212, v213
    v_cvt_pk_bf16_f32 v235, v214, v215
    ds_write_b128 v12, v[232:235] offset:4608
L_cand36:
    s_barrier
    ds_read_b128 v[176:179], v4 offset:4096
    ds_read_b128 v[180:183], v5 offset:4096
    ds_read_b128 v[184:187], v6 offset:4096
    ds_read_b128 v[188:191], v7 offset:4096
    s_waitcnt vmcnt(0)
    v_lshlrev_b32 v216, 16, v236
    v_and_b32 v217, s39, v236
    v_lshlrev_b32 v218, 16, v237
    v_and_b32 v219, s39, v237
    v_lshlrev_b32 v220, 16, v238
    v_and_b32 v221, s39, v238
    v_lshlrev_b32 v222, 16, v239
    v_and_b32 v223, s39, v239
    v_pk_mul_f32 v[216:217], v[216:217], s[40:41]
    v_pk_mul_f32 v[218:219], v[218:219], s[40:41]
    v_pk_mul_f32 v[220:221], v[220:221], s[40:41]
    v_pk_mul_f32 v[222:223], v[222:223], s[40:41]
    v_cvt_pk_bf16_f32 v236, v216, v217
    v_cvt_pk_bf16_f32 v237, v218, v219
    v_cvt_pk_bf16_f32 v238, v220, v221
    v_cvt_pk_bf16_f32 v239, v222, v223
    ds_write_b128 v12, v[236:239] offset:4736
L_cand37:
    ds_read_b128 v[48:51], v13 offset:4352
    ds_read_b128 v[52:55], v13 offset:5440
    ds_read_b128 v[56:59], v13 offset:6528
    ds_read_b128 v[60:63], v13 offset:7616
    s_waitcnt lgkmcnt(15)
    v_mfma_f32_32x32x16_bf16 v[240:255], v[192:195], v[32:35], v[16:31]
L_cand38:
    ds_read_b128 v[192:195], v4 offset:12288
    s_waitcnt lgkmcnt(15)
    v_mfma_f32_32x32x16_bf16 v[240:255], v[196:199], v[36:39], v[240:255]
L_cand39:
    ds_read_b128 v[196:199], v5 offset:12288
    s_waitcnt lgkmcnt(15)
    v_mfma_f32_32x32x16_bf16 v[240:255], v[200:203], v[40:43], v[240:255]
L_cand40:
    ds_read_b128 v[200:203], v6 offset:12288
    s_waitcnt lgkmcnt(15)
    v_mfma_f32_32x32x16_bf16 v[240:255], v[204:207], v[44:47], v[240:255]
L_cand41:
    ds_read_b128 v[204:207], v7 offset:12288
    s_waitcnt lgkmcnt(7)
    v_mfma_f32_32x32x16_bf16 v[64:79], v[176:179], v[48:51], v[64:79]
L_cand42:
    ds_read_b128 v[176:179], v4 offset:20480
    s_waitcnt lgkmcnt(7)
    v_mfma_f32_32x32x16_bf16 v[64:79], v[180:183], v[52:55], v[64:79]
L_cand43:
    ds_read_b128 v[180:183], v5 offset:20480
    s_waitcnt lgkmcnt(7)
    v_mfma_f32_32x32x16_bf16 v[64:79], v[184:187], v[56:59], v[64:79]
L_cand44:
    ds_read_b128 v[184:187], v6 offset:20480
    s_waitcnt lgkmcnt(7)
    v_mfma_f32_32x32x16_bf16 v[64:79], v[188:191], v[60:63], v[64:79]
L_cand45:
    ds_read_b128 v[188:191], v7 offset:20480
    s_waitcnt lgkmcnt(6)
    v_mfma_f32_32x32x16_bf16 v[80:95], v[192:195], v[48:51], v[80:95]
L_cand46:
    ds_read_b128 v[192:195], v4 offset:28672
    v_mfma_f32_32x32x16_bf16 v[80:95], v[196:199], v[52:55], v[80:95]
L_cand47:
    ds_read_b128 v[196:199], v5 offset:28672
    s_nop 5
    v_exp_f32 v64, v64
    v_exp_f32 v65, v65
    v_exp_f32 v66, v66
    s_waitcnt lgkmcnt(6)
    v_mfma_f32_32x32x16_bf16 v[80:95], v[200:203], v[56:59], v[80:95]
L_cand48:
    ds_read_b128 v[200:203], v6 offset:28672
    v_exp_f32 v67, v67
    v_cvt_pk_bf16_f32 v208, v64, v65
    v_mfma_f32_32x32x16_bf16 v[80:95], v[204:207], v[60:63], v[80:95]
L_cand49:
    ds_read_b128 v[204:207], v7 offset:28672
    v_exp_f32 v68, v68
    v_exp_f32 v69, v69
    v_cvt_pk_bf16_f32 v209, v66, v67
    s_waitcnt lgkmcnt(6)
    v_mfma_f32_32x32x16_bf16 v[96:111], v[176:179], v[48:51], v[96:111]
L_cand50:
    s_barrier
    ds_read_b128 v[176:179], v4 offset:36864
    v_exp_f32 v70, v70
    v_exp_f32 v71, v71
    v_mfma_f32_32x32x16_bf16 v[96:111], v[180:183], v[52:55], v[96:111]
L_cand51:
    ds_read_b128 v[180:183], v5 offset:36864
    v_cvt_pk_bf16_f32 v210, v68, v69
    v_exp_f32 v72, v72
    v_exp_f32 v73, v73
    s_waitcnt lgkmcnt(6)
    v_mfma_f32_32x32x16_bf16 v[96:111], v[184:187], v[56:59], v[96:111]
L_cand52:
    ds_read_b128 v[184:187], v6 offset:36864
    v_cvt_pk_bf16_f32 v211, v70, v71
    v_exp_f32 v74, v74
    v_mfma_f32_32x32x16_bf16 v[96:111], v[188:191], v[60:63], v[96:111]
L_cand53:
    ds_read_b128 v[188:191], v7 offset:36864
    v_exp_f32 v75, v75
    v_cvt_pk_bf16_f32 v212, v72, v73
    v_exp_f32 v76, v76
    v_mfma_f32_16x16x32_bf16 v[12:15], v[8:11], v[208:211], 0
    v_exp_f32 v77, v77
    s_waitcnt lgkmcnt(6)
    v_mfma_f32_32x32x16_bf16 v[112:127], v[192:195], v[48:51], v[112:127]
L_cand54:
    ds_read_b128 v[192:195], v4 offset:45056
    v_cvt_pk_bf16_f32 v213, v74, v75
    v_exp_f32 v78, v78
    v_mfma_f32_32x32x16_bf16 v[112:127], v[196:199], v[52:55], v[112:127]
L_cand55:
    ds_read_b128 v[196:199], v5 offset:45056
    v_exp_f32 v79, v79
    v_cvt_pk_bf16_f32 v214, v76, v77
    v_cvt_pk_bf16_f32 v215, v78, v79
    s_waitcnt lgkmcnt(6)
    v_mfma_f32_32x32x16_bf16 v[112:127], v[200:203], v[56:59], v[112:127]
L_cand56:
    ds_read_b128 v[200:203], v6 offset:45056
    v_exp_f32 v80, v80
    v_exp_f32 v81, v81
    v_mfma_f32_16x16x32_bf16 v[12:15], v[8:11], v[212:215], v[12:15]
    v_exp_f32 v82, v82
    v_mfma_f32_32x32x16_bf16 v[112:127], v[204:207], v[60:63], v[112:127]
L_cand57:
    ds_read_b128 v[204:207], v7 offset:45056
    v_exp_f32 v83, v83
    v_cvt_pk_bf16_f32 v216, v80, v81
    v_exp_f32 v84, v84
    s_waitcnt lgkmcnt(6)
    v_mfma_f32_32x32x16_bf16 v[128:143], v[176:179], v[48:51], v[128:143]
L_cand58:
    ds_read_b128 v[176:179], v4 offset:53248
    v_exp_f32 v85, v85
    v_cvt_pk_bf16_f32 v217, v82, v83
    v_mfma_f32_32x32x16_bf16 v[128:143], v[180:183], v[52:55], v[128:143]
L_cand59:
    ds_read_b128 v[180:183], v5 offset:53248
    v_exp_f32 v86, v86
    v_exp_f32 v87, v87
    v_cvt_pk_bf16_f32 v218, v84, v85
    s_waitcnt lgkmcnt(6)
    v_mfma_f32_32x32x16_bf16 v[128:143], v[184:187], v[56:59], v[128:143]
L_cand60:
    ds_read_b128 v[184:187], v6 offset:53248
    v_exp_f32 v88, v88
    v_exp_f32 v89, v89
    v_mfma_f32_32x32x16_bf16 v[128:143], v[188:191], v[60:63], v[128:143]
L_cand61:
    ds_read_b128 v[188:191], v7 offset:53248
    v_cvt_pk_bf16_f32 v219, v86, v87
    v_exp_f32 v90, v90
    v_exp_f32 v91, v91
    v_mfma_f32_16x16x32_bf16 v[12:15], v[8:11], v[216:219], v[12:15]
    v_cvt_pk_bf16_f32 v220, v88, v89
    s_waitcnt lgkmcnt(6)
    v_mfma_f32_32x32x16_bf16 v[144:159], v[192:195], v[48:51], v[144:159]
L_cand62:
    ds_read_b128 v[192:195], v4 offset:61440
    v_exp_f32 v92, v92
    v_exp_f32 v93, v93
    v_mfma_f32_32x32x16_bf16 v[144:159], v[196:199], v[52:55], v[144:159]
L_cand63:
    ds_read_b128 v[196:199], v5 offset:61440
    v_cvt_pk_bf16_f32 v221, v90, v91
    v_exp_f32 v94, v94
    v_exp_f32 v95, v95
    s_waitcnt lgkmcnt(6)
    v_mfma_f32_32x32x16_bf16 v[144:159], v[200:203], v[56:59], v[144:159]
L_cand64:
    s_barrier
    ds_read_b128 v[200:203], v6 offset:61440
    v_cvt_pk_bf16_f32 v222, v92, v93
    v_cvt_pk_bf16_f32 v223, v94, v95
    v_mfma_f32_32x32x16_bf16 v[144:159], v[204:207], v[60:63], v[144:159]
L_cand65:
    ds_read_b128 v[204:207], v7 offset:61440
    v_exp_f32 v96, v96
    v_exp_f32 v97, v97
    v_exp_f32 v98, v98
    v_mfma_f32_16x16x32_bf16 v[12:15], v[8:11], v[220:223], v[12:15]
    v_exp_f32 v99, v99
    s_waitcnt lgkmcnt(6)
    v_mfma_f32_32x32x16_bf16 v[160:175], v[176:179], v[48:51], v[160:175]
L_cand66:
    ds_read_b64_tr_b16 v[176:177], v2 offset:0
    ds_read_b64_tr_b16 v[178:179], v2 offset:1024
    v_cvt_pk_bf16_f32 v224, v96, v97
    v_exp_f32 v100, v100
    v_mfma_f32_32x32x16_bf16 v[160:175], v[180:183], v[52:55], v[160:175]
L_cand67:
    ds_read_b64_tr_b16 v[180:181], v2 offset:2048
    ds_read_b64_tr_b16 v[182:183], v2 offset:3072
    v_exp_f32 v101, v101
    v_cvt_pk_bf16_f32 v225, v98, v99
    v_exp_f32 v102, v102
    s_waitcnt lgkmcnt(8)
    v_mfma_f32_32x32x16_bf16 v[160:175], v[184:187], v[56:59], v[160:175]
L_pad68:
    s_cbranch_execz L_lback
    ds_read_b64_tr_b16 v[184:185], v2 offset:8192
    ds_read_b64_tr_b16 v[186:187], v2 offset:9216
    v_exp_f32 v103, v103
    v_cvt_pk_bf16_f32 v226, v100, v101
    v_mfma_f32_32x32x16_bf16 v[160:175], v[188:191], v[60:63], v[160:175]
L_cand69:
    ds_read_b64_tr_b16 v[188:189], v2 offset:10240
    ds_read_b64_tr_b16 v[190:191], v2 offset:11264
    v_exp_f32 v104, v104
    v_exp_f32 v105, v105
    v_cvt_pk_bf16_f32 v227, v102, v103
    s_waitcnt lgkmcnt(10)
    v_mfma_f32_32x32x16_bf16 v[240:255], v[192:195], v[48:51], v[240:255]
L_cand70:
    ds_read_b64_tr_b16 v[192:193], v3 offset:0
    ds_read_b64_tr_b16 v[194:195], v3 offset:1024
    v_exp_f32 v106, v106
    v_exp_f32 v107, v107
    v_mfma_f32_16x16x32_bf16 v[12:15], v[8:11], v[224:227], v[12:15]
    v_cvt_pk_bf16_f32 v228, v104, v105
    v_mfma_f32_32x32x16_bf16 v[240:255], v[196:199], v[52:55], v[240:255]
L_cand71:
    ds_read_b64_tr_b16 v[196:197], v3 offset:2048
    ds_read_b64_tr_b16 v[198:199], v3 offset:3072
    v_exp_f32 v108, v108
    v_exp_f32 v109, v109
    v_cvt_pk_bf16_f32 v229, v106, v107
    s_waitcnt lgkmcnt(12)
    v_mfma_f32_32x32x16_bf16 v[240:255], v[200:203], v[56:59], v[240:255]
L_cand72:
    ds_read_b64_tr_b16 v[200:201], v3 offset:8192
    ds_read_b64_tr_b16 v[202:203], v3 offset:9216
    v_exp_f32 v110, v110
    v_exp_f32 v111, v111
    v_mfma_f32_32x32x16_bf16 v[240:255], v[204:207], v[60:63], v[240:255]
L_cand73:
    s_barrier
    ds_read_b64_tr_b16 v[204:205], v3 offset:10240
    ds_read_b64_tr_b16 v[206:207], v3 offset:11264
    v_cvt_pk_bf16_f32 v230, v108, v109
    v_cvt_pk_bf16_f32 v231, v110, v111
    v_exp_f32 v112, v112
    s_waitcnt lgkmcnt(12)
    v_mfma_f32_32x32x16_bf16 v[64:79], v[176:179], v[208:211], 0
L_cand74:
    ds_read_b64_tr_b16 v[176:177], v2 offset:16384
    ds_read_b64_tr_b16 v[178:179], v2 offset:17408
    v_exp_f32 v113, v113
    v_exp_f32 v114, v114
    v_mfma_f32_16x16x32_bf16 v[12:15], v[8:11], v[228:231], v[12:15]
    v_exp_f32 v115, v115
    v_mfma_f32_32x32x16_bf16 v[64:79], v[180:183], v[212:215], v[64:79]
L_cand75:
    ds_read_b64_tr_b16 v[180:181], v2 offset:18432
    ds_read_b64_tr_b16 v[182:183], v2 offset:19456
    v_cvt_pk_bf16_f32 v232, v112, v113
    v_exp_f32 v116, v116
    v_exp_f32 v117, v117
    s_waitcnt lgkmcnt(12)
    v_mfma_f32_32x32x16_bf16 v[64:79], v[184:187], v[216:219], v[64:79]
L_cand76:
    ds_read_b64_tr_b16 v[184:185], v3 offset:16384
    ds_read_b64_tr_b16 v[186:187], v3 offset:17408
    v_cvt_pk_bf16_f32 v233, v114, v115
    v_exp_f32 v118, v118
    v_mfma_f32_32x32x16_bf16 v[64:79], v[188:191], v[220:223], v[64:79]
L_cand77:
    ds_read_b64_tr_b16 v[188:189], v3 offset:18432
    ds_read_b64_tr_b16 v[190:191], v3 offset:19456
    v_exp_f32 v119, v119
    v_cvt_pk_bf16_f32 v234, v116, v117
    v_exp_f32 v120, v120
    s_waitcnt lgkmcnt(12)
    v_mfma_f32_32x32x16_bf16 v[80:95], v[192:195], v[208:211], 0
L_cand78:
    ds_read_b64_tr_b16 v[192:193], v2 offset:4096
    ds_read_b64_tr_b16 v[194:195], v2 offset:5120
    v_exp_f32 v121, v121
    v_cvt_pk_bf16_f32 v235, v118, v119
    v_mfma_f32_32x32x16_bf16 v[80:95], v[196:199], v[212:215], v[80:95]
L_cand79:
    ds_read_b64_tr_b16 v[196:197], v2 offset:6144
    ds_read_b64_tr_b16 v[198:199], v2 offset:7168
    v_exp_f32 v122, v122
    v_exp_f32 v123, v123
    v_cvt_pk_bf16_f32 v236, v120, v121
    v_mfma_f32_16x16x32_bf16 v[12:15], v[8:11], v[232:235], v[12:15]
    v_exp_f32 v124, v124
    s_waitcnt lgkmcnt(12)
    v_mfma_f32_32x32x16_bf16 v[80:95], v[200:203], v[216:219], v[80:95]
L_cand80:
    ds_read_b64_tr_b16 v[200:201], v2 offset:12288
    ds_read_b64_tr_b16 v[202:203], v2 offset:13312
    v_exp_f32 v125, v125
    v_cvt_pk_bf16_f32 v237, v122, v123
    v_mfma_f32_32x32x16_bf16 v[80:95], v[204:207], v[220:223], v[80:95]
L_cand81:
    ds_read_b64_tr_b16 v[204:205], v2 offset:14336
    ds_read_b64_tr_b16 v[206:207], v2 offset:15360
    v_exp_f32 v126, v126
    v_exp_f32 v127, v127
    v_cvt_pk_bf16_f32 v238, v124, v125
    s_waitcnt lgkmcnt(12)
    v_mfma_f32_32x32x16_bf16 v[64:79], v[176:179], v[224:227], v[64:79]
L_cand82:
    ds_read_b64_tr_b16 v[176:177], v2 offset:20480
    ds_read_b64_tr_b16 v[178:179], v2 offset:21504
    v_cvt_pk_bf16_f32 v239, v126, v127
    v_exp_f32 v128, v128
    v_mfma_f32_32x32x16_bf16 v[64:79], v[180:183], v[228:231], v[64:79]
L_cand83:
    ds_read_b64_tr_b16 v[180:181], v2 offset:22528
    ds_read_b64_tr_b16 v[182:183], v2 offset:23552
    v_exp_f32 v129, v129
    v_exp_f32 v130, v130
    v_exp_f32 v131, v131
    v_mfma_f32_16x16x32_bf16 v[12:15], v[8:11], v[236:239], v[12:15]
    s_waitcnt lgkmcnt(12)
    v_mfma_f32_32x32x16_bf16 v[80:95], v[184:187], v[224:227], v[80:95]
L_cand84:
    ds_read_b64_tr_b16 v[184:185], v3 offset:4096
    ds_read_b64_tr_b16 v[186:187], v3 offset:5120
    v_mfma_f32_32x32x16_bf16 v[80:95], v[188:191], v[228:231], v[80:95]
L_cand85:
    ds_read_b64_tr_b16 v[188:189], v3 offset:6144
    ds_read_b64_tr_b16 v[190:191], v3 offset:7168
    s_waitcnt lgkmcnt(12)
    v_mfma_f32_32x32x16_bf16 v[96:111], v[192:195], v[208:211], 0
L_cand86:
    ds_read_b64_tr_b16 v[192:193], v3 offset:12288
    ds_read_b64_tr_b16 v[194:195], v3 offset:13312
    v_mfma_f32_32x32x16_bf16 v[96:111], v[196:199], v[212:215], v[96:111]
L_cand87:
    ds_read_b64_tr_b16 v[196:197], v3 offset:14336
    ds_read_b64_tr_b16 v[198:199], v3 offset:15360
    s_waitcnt lgkmcnt(12)
    v_mfma_f32_32x32x16_bf16 v[96:111], v[200:203], v[216:219], v[96:111]
L_cand88:
    ds_read_b64_tr_b16 v[200:201], v3 offset:20480
    ds_read_b64_tr_b16 v[202:203], v3 offset:21504
    v_mfma_f32_32x32x16_bf16 v[96:111], v[204:207], v[220:223], v[96:111]
L_cand89:
    ds_read_b64_tr_b16 v[204:205], v3 offset:22528
    ds_read_b64_tr_b16 v[206:207], v3 offset:23552
    s_waitcnt lgkmcnt(12)
    v_mfma_f32_32x32x16_bf16 v[96:111], v[176:179], v[224:227], v[96:111]
L_cand90:
    ds_read_b64_tr_b16 v[176:177], v2 offset:24576
    ds_read_b64_tr_b16 v[178:179], v2 offset:25600
    v_mfma_f32_32x32x16_bf16 v[96:111], v[180:183], v[228:231], v[96:111]
L_cand91:
    ds_read_b64_tr_b16 v[180:181], v3 offset:24576
    ds_read_b64_tr_b16 v[182:183], v3 offset:25600
    s_waitcnt lgkmcnt(12)
    v_mfma_f32_32x32x16_bf16 v[112:127], v[184:187], v[208:211], 0
L_cand92:
    ds_read_b64_tr_b16 v[184:185], v2 offset:28672
    ds_read_b64_tr_b16 v[186:187], v2 offset:29696
    v_cvt_pk_bf16_f32 v208, v128, v129
    v_exp_f32 v132, v132
    v_mfma_f32_32x32x16_bf16 v[112:127], v[188:191], v[212:215], v[112:127]
L_cand93:
    ds_read_b64_tr_b16 v[188:189], v3 offset:28672
    ds_read_b64_tr_b16 v[190:191], v3 offset:29696
    v_exp_f32 v133, v133
    v_cvt_pk_bf16_f32 v209, v130, v131
    v_exp_f32 v134, v134
    s_waitcnt lgkmcnt(12)
    v_mfma_f32_32x32x16_bf16 v[112:127], v[192:195], v[216:219], v[112:127]
L_cand94:
    ds_read_b64_tr_b16 v[192:193], v2 offset:26624
    ds_read_b64_tr_b16 v[194:195], v2 offset:27648
    v_exp_f32 v135, v135
    v_cvt_pk_bf16_f32 v210, v132, v133
    v_mfma_f32_32x32x16_bf16 v[112:127], v[196:199], v[220:223], v[112:127]
L_cand95:
    ds_read_b64_tr_b16 v[196:197], v3 offset:26624
    ds_read_b64_tr_b16 v[198:199], v3 offset:27648
    v_exp_f32 v136, v136
    v_exp_f32 v137, v137
    v_cvt_pk_bf16_f32 v211, v134, v135
    s_waitcnt lgkmcnt(12)
    v_mfma_f32_32x32x16_bf16 v[112:127], v[200:203], v[224:227], v[112:127]
L_cand96:
    s_barrier
    ds_read_b64_tr_b16 v[200:201], v2 offset:30720
    ds_read_b64_tr_b16 v[202:203], v2 offset:31744
    v_exp_f32 v138, v138
    v_exp_f32 v139, v139
    v_mfma_f32_16x16x32_bf16 v[12:15], v[8:11], v[208:211], v[12:15]
    v_cvt_pk_bf16_f32 v212, v136, v137
    v_mfma_f32_32x32x16_bf16 v[112:127], v[204:207], v[228:231], v[112:127]
L_cand97:
    ds_read_b64_tr_b16 v[204:205], v3 offset:30720
    ds_read_b64_tr_b16 v[206:207], v3 offset:31744
    v_exp_f32 v140, v140
    v_exp_f32 v141, v141
    v_cvt_pk_bf16_f32 v213, v138, v139
    s_waitcnt lgkmcnt(12)
    v_mfma_f32_32x32x16_bf16 v[64:79], v[176:179], v[232:235], v[64:79]
L_cand98:
    ds_read_b64_tr_b16 v[176:177], v2 offset:32768
    ds_read_b64_tr_b16 v[178:179], v2 offset:33792
    v_exp_f32 v142, v142
    v_exp_f32 v143, v143
    v_mfma_f32_32x32x16_bf16 v[80:95], v[180:183], v[232:235], v[80:95]
L_cand99:
    ds_read_b64_tr_b16 v[180:181], v3 offset:32768
    ds_read_b64_tr_b16 v[182:183], v3 offset:33792
    v_cvt_pk_bf16_f32 v214, v140, v141
    v_cvt_pk_bf16_f32 v215, v142, v143
    v_exp_f32 v144, v144
    s_waitcnt lgkmcnt(12)
    v_mfma_f32_32x32x16_bf16 v[96:111], v[184:187], v[232:235], v[96:111]
L_cand100:
    ds_read_b64_tr_b16 v[184:185], v2 offset:36864
    ds_read_b64_tr_b16 v[186:187], v2 offset:37888
    v_exp_f32 v145, v145
    v_exp_f32 v146, v146
    v_mfma_f32_16x16x32_bf16 v[12:15], v[8:11], v[212:215], v[12:15]
    v_exp_f32 v147, v147
    v_mfma_f32_32x32x16_bf16 v[112:127], v[188:191], v[232:235], v[112:127]
L_cand101:
    ds_read_b64_tr_b16 v[188:189], v3 offset:36864
    ds_read_b64_tr_b16 v[190:191], v3 offset:37888
    v_cvt_pk_bf16_f32 v216, v144, v145
    v_exp_f32 v148, v148
    v_exp_f32 v149, v149
    s_waitcnt lgkmcnt(12)
    v_mfma_f32_32x32x16_bf16 v[64:79], v[192:195], v[236:239], v[64:79]
L_cand102:
    ds_read_b64_tr_b16 v[192:193], v2 offset:34816
    ds_read_b64_tr_b16 v[194:195], v2 offset:35840
    v_cvt_pk_bf16_f32 v217, v146, v147
    v_exp_f32 v150, v150
    v_mfma_f32_32x32x16_bf16 v[80:95], v[196:199], v[236:239], v[80:95]
L_cand103:
    ds_read_b64_tr_b16 v[196:197], v3 offset:34816
    ds_read_b64_tr_b16 v[198:199], v3 offset:35840
    v_exp_f32 v151, v151
    v_cvt_pk_bf16_f32 v218, v148, v149
    v_exp_f32 v152, v152
    s_waitcnt lgkmcnt(12)
    v_mfma_f32_32x32x16_bf16 v[96:111], v[200:203], v[236:239], v[96:111]
L_cand104:
    ds_read_b64_tr_b16 v[200:201], v2 offset:38912
    ds_read_b64_tr_b16 v[202:203], v2 offset:39936
    v_exp_f32 v153, v153
    v_cvt_pk_bf16_f32 v219, v150, v151
    v_mfma_f32_32x32x16_bf16 v[112:127], v[204:207], v[236:239], v[112:127]
L_cand105:
    ds_read_b64_tr_b16 v[204:205], v3 offset:38912
    ds_read_b64_tr_b16 v[206:207], v3 offset:39936
    v_exp_f32 v154, v154
    v_exp_f32 v155, v155
    v_cvt_pk_bf16_f32 v220, v152, v153
    v_mfma_f32_16x16x32_bf16 v[12:15], v[8:11], v[216:219], v[12:15]
    v_exp_f32 v156, v156
    s_waitcnt lgkmcnt(12)
    v_mfma_f32_32x32x16_bf16 v[64:79], v[176:179], v[208:211], v[64:79]
L_cand106:
    s_barrier
    ds_read_b128 v[176:179], v4 offset:0
    v_exp_f32 v157, v157
    v_cvt_pk_bf16_f32 v221, v154, v155
    v_mfma_f32_32x32x16_bf16 v[80:95], v[180:183], v[208:211], v[80:95]
L_cand107:
    ds_read_b128 v[180:183], v5 offset:0
    v_exp_f32 v158, v158
    v_exp_f32 v159, v159
    s_waitcnt lgkmcnt(10)
    v_mfma_f32_32x32x16_bf16 v[96:111], v[184:187], v[208:211], v[96:111]
L_cand108:
    ds_read_b128 v[184:187], v6 offset:0
    v_cvt_pk_bf16_f32 v222, v156, v157
    v_cvt_pk_bf16_f32 v223, v158, v159
    v_mfma_f32_32x32x16_bf16 v[112:127], v[188:191], v[208:211], v[112:127]
L_cand109:
    ds_read_b128 v[188:191], v7 offset:0
    v_exp_f32 v160, v160
    v_exp_f32 v161, v161
    v_mfma_f32_16x16x32_bf16 v[12:15], v[8:11], v[220:223], v[12:15]
    v_exp_f32 v162, v162
    s_waitcnt lgkmcnt(8)
    v_mfma_f32_32x32x16_bf16 v[64:79], v[192:195], v[212:215], v[64:79]
L_cand110:
    ds_read_b128 v[192:195], v4 offset:4096
    v_exp_f32 v163, v163
    v_cvt_pk_bf16_f32 v224, v160, v161
    v_mfma_f32_32x32x16_bf16 v[80:95], v[196:199], v[212:215], v[80:95]
L_cand111:
    ds_read_b128 v[196:199], v5 offset:4096
    v_exp_f32 v164, v164
    v_exp_f32 v165, v165
    s_waitcnt lgkmcnt(6)
    v_mfma_f32_32x32x16_bf16 v[96:111], v[200:203], v[212:215], v[96:111]
L_cand112:
    ds_read_b128 v[200:203], v6 offset:4096
    v_cvt_pk_bf16_f32 v225, v162, v163
    v_exp_f32 v166, v166
    v_mfma_f32_32x32x16_bf16 v[112:127], v[204:207], v[212:215], v[112:127]
L_cand113:
    ds_read_b128 v[204:207], v7 offset:4096
    v_exp_f32 v167, v167
    v_cvt_pk_bf16_f32 v226, v164, v165
    s_waitcnt lgkmcnt(6)
    v_mfma_f32_32x32x16_bf16 v[128:143], v[176:179], v[32:35], v[16:31]
L_cand114:
    ds_read_b64_tr_b16 v[176:177], v2 offset:40960
    ds_read_b64_tr_b16 v[178:179], v2 offset:41984
    v_exp_f32 v168, v168
    v_exp_f32 v169, v169
    v_mfma_f32_32x32x16_bf16 v[128:143], v[180:183], v[36:39], v[128:143]
L_cand115:
    ds_read_b64_tr_b16 v[180:181], v3 offset:40960
    ds_read_b64_tr_b16 v[182:183], v3 offset:41984
    v_cvt_pk_bf16_f32 v227, v166, v167
    v_exp_f32 v170, v170
    s_waitcnt lgkmcnt(8)
    v_mfma_f32_32x32x16_bf16 v[128:143], v[184:187], v[40:43], v[128:143]
L_cand116:
    ds_read_b64_tr_b16 v[184:185], v2 offset:45056
    ds_read_b64_tr_b16 v[186:187], v2 offset:46080
    v_exp_f32 v171, v171
    v_cvt_pk_bf16_f32 v228, v168, v169
    v_mfma_f32_16x16x32_bf16 v[12:15], v[8:11], v[224:227], v[12:15]
    v_exp_f32 v172, v172
    v_mfma_f32_32x32x16_bf16 v[128:143], v[188:191], v[44:47], v[128:143]
L_cand117:
    ds_read_b64_tr_b16 v[188:189], v3 offset:45056
    ds_read_b64_tr_b16 v[190:191], v3 offset:46080
    v_exp_f32 v173, v173
    v_cvt_pk_bf16_f32 v229, v170, v171
    s_waitcnt lgkmcnt(10)
    v_mfma_f32_32x32x16_bf16 v[128:143], v[192:195], v[48:51], v[128:143]
L_cand118:
    ds_read_b64_tr_b16 v[192:193], v2 offset:43008
    ds_read_b64_tr_b16 v[194:195], v2 offset:44032
    v_exp_f32 v174, v174
    v_exp_f32 v175, v175
    v_mfma_f32_32x32x16_bf16 v[128:143], v[196:199], v[52:55], v[128:143]
L_cand119:
    ds_read_b64_tr_b16 v[196:197], v3 offset:43008
    ds_read_b64_tr_b16 v[198:199], v3 offset:44032
    v_cvt_pk_bf16_f32 v230, v172, v173
    v_cvt_pk_bf16_f32 v231, v174, v175
    s_waitcnt lgkmcnt(12)
    v_mfma_f32_32x32x16_bf16 v[128:143], v[200:203], v[56:59], v[128:143]
L_cand120:
    ds_read_b64_tr_b16 v[200:201], v2 offset:47104
    ds_read_b64_tr_b16 v[202:203], v2 offset:48128
    v_exp_f32 v240, v240
    v_exp_f32 v241, v241
    v_mfma_f32_16x16x32_bf16 v[12:15], v[8:11], v[228:231], v[12:15]
    v_exp_f32 v242, v242
    v_mfma_f32_32x32x16_bf16 v[128:143], v[204:207], v[60:63], v[128:143]
L_cand121:
    ds_read_b64_tr_b16 v[204:205], v3 offset:47104
    ds_read_b64_tr_b16 v[206:207], v3 offset:48128
    v_exp_f32 v243, v243
    v_cvt_pk_bf16_f32 v232, v240, v241
    s_waitcnt lgkmcnt(12)
    v_mfma_f32_32x32x16_bf16 v[64:79], v[176:179], v[216:219], v[64:79]
L_cand122:
    s_barrier
    ds_read_b128 v[176:179], v4 offset:8192
    v_exp_f32 v244, v244
    v_exp_f32 v245, v245
    v_mfma_f32_32x32x16_bf16 v[80:95], v[180:183], v[216:219], v[80:95]
L_cand123:
    ds_read_b128 v[180:183], v5 offset:8192
    v_cvt_pk_bf16_f32 v233, v242, v243
    v_exp_f32 v246, v246
    s_waitcnt lgkmcnt(10)
    v_mfma_f32_32x32x16_bf16 v[96:111], v[184:187], v[216:219], v[96:111]
L_cand124:
    ds_read_b128 v[184:187], v6 offset:8192
    v_exp_f32 v247, v247
    v_cvt_pk_bf16_f32 v234, v244, v245
    v_mfma_f32_32x32x16_bf16 v[112:127], v[188:191], v[216:219], v[112:127]
L_cand125:
    ds_read_b128 v[188:191], v7 offset:8192
    v_exp_f32 v248, v248
    v_exp_f32 v249, v249
    s_waitcnt lgkmcnt(8)
    v_mfma_f32_32x32x16_bf16 v[64:79], v[192:195], v[220:223], v[64:79]
L_cand126:
    ds_read_b128 v[192:195], v4 offset:12288
    v_cvt_pk_bf16_f32 v235, v246, v247
    v_exp_f32 v250, v250
    v_mfma_f32_32x32x16_bf16 v[80:95], v[196:199], v[220:223], v[80:95]
L_cand127:
    ds_read_b128 v[196:199], v5 offset:12288
    v_exp_f32 v251, v251
    v_cvt_pk_bf16_f32 v236, v248, v249
    v_mfma_f32_16x16x32_bf16 v[12:15], v[8:11], v[232:235], v[12:15]
    v_exp_f32 v252, v252
    s_waitcnt lgkmcnt(6)
    v_mfma_f32_32x32x16_bf16 v[96:111], v[200:203], v[220:223], v[96:111]
L_cand128:
    ds_read_b128 v[200:203], v6 offset:12288
    v_exp_f32 v253, v253
    v_cvt_pk_bf16_f32 v237, v250, v251
    v_mfma_f32_32x32x16_bf16 v[112:127], v[204:207], v[220:223], v[112:127]
L_cand129:
    ds_read_b128 v[204:207], v7 offset:12288
    v_exp_f32 v254, v254
    v_exp_f32 v255, v255
    s_waitcnt lgkmcnt(6)
    v_mfma_f32_32x32x16_bf16 v[144:159], v[176:179], v[32:35], v[16:31]
L_cand130:
    ds_read_b64_tr_b16 v[176:177], v2 offset:49152
    ds_read_b64_tr_b16 v[178:179], v2 offset:50176
    v_cvt_pk_bf16_f32 v238, v252, v253
    v_cvt_pk_bf16_f32 v239, v254, v255
    v_mfma_f32_32x32x16_bf16 v[144:159], v[180:183], v[36:39], v[144:159]
L_cand131:
    ds_read_b64_tr_b16 v[240:241], v3 offset:49152
    ds_read_b64_tr_b16 v[242:243], v3 offset:50176
    ds_read_b64_tr_b16 v[244:245], v2 offset:53248
    ds_read_b64_tr_b16 v[246:247], v2 offset:54272
    v_exp_f32 v128, v128
    v_exp_f32 v129, v129
    v_mfma_f32_16x16x32_bf16 v[12:15], v[8:11], v[236:239], v[12:15]
    v_exp_f32 v130, v130
    s_waitcnt lgkmcnt(10)
    v_mfma_f32_32x32x16_bf16 v[144:159], v[184:187], v[40:43], v[144:159]
L_cand132:
    ds_read_b64_tr_b16 v[248:249], v3 offset:53248
    ds_read_b64_tr_b16 v[250:251], v3 offset:54272
    ds_read_b64_tr_b16 v[252:253], v2 offset:51200
    ds_read_b64_tr_b16 v[254:255], v2 offset:52224
    v_exp_f32 v131, v131
    v_cvt_pk_bf16_f32 v208, v128, v129
    v_mfma_f32_32x32x16_bf16 v[144:159], v[188:191], v[44:47], v[144:159]
L_cand133:
    ds_read_b64_tr_b16 v[180:181], v3 offset:51200
    ds_read_b64_tr_b16 v[182:183], v3 offset:52224
    ds_read_b64_tr_b16 v[184:185], v2 offset:55296
    ds_read_b64_tr_b16 v[186:187], v2 offset:56320
    v_exp_f32 v132, v132
    v_exp_f32 v133, v133
    s_waitcnt lgkmcnt(15)
    v_mfma_f32_32x32x16_bf16 v[144:159], v[192:195], v[48:51], v[144:159]
L_cand134:
    ds_read_b64_tr_b16 v[188:189], v3 offset:55296
    ds_read_b64_tr_b16 v[190:191], v3 offset:56320
    ds_read_b128 v[192:195], v4 offset:16384
    v_cvt_pk_bf16_f32 v209, v130, v131
    v_exp_f32 v134, v134
    v_mfma_f32_32x32x16_bf16 v[144:159], v[196:199], v[52:55], v[144:159]
L_cand135:
    ds_read_b128 v[196:199], v5 offset:16384
    v_exp_f32 v135, v135
    v_cvt_pk_bf16_f32 v210, v132, v133
    s_waitcnt lgkmcnt(15)
    v_mfma_f32_32x32x16_bf16 v[144:159], v[200:203], v[56:59], v[144:159]
L_cand136:
    ds_read_b128 v[200:203], v6 offset:16384
    v_exp_f32 v136, v136
    v_exp_f32 v137, v137
    v_mfma_f32_32x32x16_bf16 v[144:159], v[204:207], v[60:63], v[144:159]
L_cand137:
    ds_read_b128 v[204:207], v7 offset:16384
    v_cvt_pk_bf16_f32 v211, v134, v135
    v_exp_f32 v138, v138
    s_waitcnt lgkmcnt(12)
    v_mfma_f32_32x32x16_bf16 v[64:79], v[176:179], v[224:227], v[64:79]
L_cand138:
    s_barrier
    ds_read_b128 v[176:179], v4 offset:20480
    v_exp_f32 v139, v139
    v_cvt_pk_bf16_f32 v212, v136, v137
    v_mfma_f32_16x16x32_bf16 v[12:15], v[8:11], v[208:211], v[12:15]
    v_exp_f32 v140, v140
    v_mfma_f32_32x32x16_bf16 v[80:95], v[240:243], v[224:227], v[80:95]
L_cand139:
    ds_read_b128 v[240:243], v5 offset:20480
    v_exp_f32 v141, v141
    v_cvt_pk_bf16_f32 v213, v138, v139
    v_mfma_f32_32x32x16_bf16 v[96:111], v[244:247], v[224:227], v[96:111]
L_cand140:
    ds_read_b128 v[244:247], v6 offset:20480
    v_exp_f32 v142, v142
    v_exp_f32 v143, v143
    v_mfma_f32_32x32x16_bf16 v[112:127], v[248:251], v[224:227], v[112:127]
L_cand141:
    ds_read_b128 v[248:251], v7 offset:20480
    v_cvt_pk_bf16_f32 v214, v140, v141
    v_cvt_pk_bf16_f32 v215, v142, v143
    s_waitcnt lgkmcnt(8)
    v_mfma_f32_32x32x16_bf16 v[64:79], v[252:255], v[228:231], v[64:79]
L_cand142:
    ds_read_b64_tr_b16 v[252:253], v2 offset:57344
    ds_read_b64_tr_b16 v[254:255], v2 offset:58368
    v_exp_f32 v144, v144
    v_exp_f32 v145, v145
    v_mfma_f32_16x16x32_bf16 v[12:15], v[8:11], v[212:215], v[12:15]
    v_exp_f32 v146, v146
    v_mfma_f32_32x32x16_bf16 v[80:95], v[180:183], v[228:231], v[80:95]
L_cand143:
    ds_read_b64_tr_b16 v[180:181], v3 offset:57344
    ds_read_b64_tr_b16 v[182:183], v3 offset:58368
    v_exp_f32 v147, v147
    v_cvt_pk_bf16_f32 v216, v144, v145
    v_mfma_f32_32x32x16_bf16 v[96:111], v[184:187], v[228:231], v[96:111]
L_cand144:
    ds_read_b64_tr_b16 v[184:185], v2 offset:61440
    ds_read_b64_tr_b16 v[186:187], v2 offset:62464
    v_exp_f32 v148, v148
    v_exp_f32 v149, v149
    v_mfma_f32_32x32x16_bf16 v[112:127], v[188:191], v[228:231], v[112:127]
L_cand145:
    ds_read_b64_tr_b16 v[188:189], v3 offset:61440
    ds_read_b64_tr_b16 v[190:191], v3 offset:62464
    v_cvt_pk_bf16_f32 v217, v146, v147
    v_exp_f32 v150, v150
    s_waitcnt lgkmcnt(12)
    v_mfma_f32_32x32x16_bf16 v[160:175], v[192:195], v[32:35], v[16:31]
L_cand146:
    ds_read_b64_tr_b16 v[192:193], v2 offset:59392
    ds_read_b64_tr_b16 v[194:195], v2 offset:60416
    v_exp_f32 v151, v151
    v_cvt_pk_bf16_f32 v218, v148, v149
    v_mfma_f32_32x32x16_bf16 v[160:175], v[196:199], v[36:39], v[160:175]
L_cand147:
    ds_read_b64_tr_b16 v[196:197], v3 offset:59392
    ds_read_b64_tr_b16 v[198:199], v3 offset:60416
    v_exp_f32 v152, v152
    v_exp_f32 v153, v153
    v_mfma_f32_32x32x16_bf16 v[160:175], v[200:203], v[40:43], v[160:175]
L_cand148:
    ds_read_b64_tr_b16 v[200:201], v2 offset:63488
    ds_read_b64_tr_b16 v[202:203], v2 offset:64512
    v_cvt_pk_bf16_f32 v219, v150, v151
    v_exp_f32 v154, v154
    v_mfma_f32_32x32x16_bf16 v[160:175], v[204:207], v[44:47], v[160:175]
L_cand149:
    ds_read_b64_tr_b16 v[204:205], v3 offset:63488
    ds_read_b64_tr_b16 v[206:207], v3 offset:64512
    v_exp_f32 v155, v155
    v_cvt_pk_bf16_f32 v220, v152, v153
    v_mfma_f32_16x16x32_bf16 v[12:15], v[8:11], v[216:219], v[12:15]
    v_exp_f32 v156, v156
    s_waitcnt lgkmcnt(15)
    v_mfma_f32_32x32x16_bf16 v[160:175], v[176:179], v[48:51], v[160:175]
L_cand150:
    ds_read_b128 v[176:179], v4 offset:24576
    v_exp_f32 v157, v157
    v_cvt_pk_bf16_f32 v221, v154, v155
    v_mfma_f32_32x32x16_bf16 v[160:175], v[240:243], v[52:55], v[160:175]
L_cand151:
    ds_read_b128 v[240:243], v5 offset:24576
    v_exp_f32 v158, v158
    v_exp_f32 v159, v159
    v_mfma_f32_32x32x16_bf16 v[160:175], v[244:247], v[56:59], v[160:175]
L_cand152:
    ds_read_b128 v[244:247], v6 offset:24576
    v_cvt_pk_bf16_f32 v222, v156, v157
    v_cvt_pk_bf16_f32 v223, v158, v159
    v_mfma_f32_32x32x16_bf16 v[160:175], v[248:251], v[60:63], v[160:175]
L_cand153:
    ds_read_b128 v[248:251], v7 offset:24576
    s_waitcnt lgkmcnt(12)
    v_mfma_f32_32x32x16_bf16 v[64:79], v[252:255], v[232:235], v[64:79]
L_cand154:
    s_barrier
    ds_read_b128 v[252:255], v4 offset:28672
    v_mfma_f32_16x16x32_bf16 v[12:15], v[8:11], v[220:223], v[12:15]
    v_mfma_f32_32x32x16_bf16 v[80:95], v[180:183], v[232:235], v[80:95]
L_cand155:
    ds_read_b128 v[180:183], v5 offset:28672
    s_nop 3
    v_exp_f32 v160, v160
    v_exp_f32 v161, v161
    v_mfma_f32_32x32x16_bf16 v[96:111], v[184:187], v[232:235], v[96:111]
L_cand156:
    ds_read_b128 v[184:187], v6 offset:28672
    v_exp_f32 v162, v162
    v_exp_f32 v163, v163
    v_mfma_f32_32x32x16_bf16 v[112:127], v[188:191], v[232:235], v[112:127]
L_cand157:
    ds_read_b128 v[188:191], v7 offset:28672
    v_cvt_pk_bf16_f32 v224, v160, v161
    v_exp_f32 v164, v164
    s_waitcnt lgkmcnt(8)
    v_mfma_f32_32x32x16_bf16 v[64:79], v[192:195], v[236:239], v[64:79]
L_cand158:
    ds_read_b64_tr_b16 v[192:193], v2 offset:0
    ds_read_b64_tr_b16 v[194:195], v2 offset:1024
    v_exp_f32 v165, v165
    v_cvt_pk_bf16_f32 v225, v162, v163
    v_mfma_f32_32x32x16_bf16 v[80:95], v[196:199], v[236:239], v[80:95]
L_cand159:
    ds_read_b64_tr_b16 v[196:197], v3 offset:0
    ds_read_b64_tr_b16 v[198:199], v3 offset:1024
    v_exp_f32 v166, v166
    v_exp_f32 v167, v167
    v_mfma_f32_32x32x16_bf16 v[96:111], v[200:203], v[236:239], v[96:111]
L_cand160:
    ds_read_b64_tr_b16 v[200:201], v2 offset:4096
    ds_read_b64_tr_b16 v[202:203], v2 offset:5120
    v_cvt_pk_bf16_f32 v226, v164, v165
    v_exp_f32 v168, v168
    v_mfma_f32_32x32x16_bf16 v[112:127], v[204:207], v[236:239], v[112:127]
L_cand161:
    ds_read_b64_tr_b16 v[204:205], v3 offset:4096
    ds_read_b64_tr_b16 v[206:207], v3 offset:5120
    v_exp_f32 v169, v169
    v_cvt_pk_bf16_f32 v227, v166, v167
    s_waitcnt lgkmcnt(12)
    v_mfma_f32_32x32x16_bf16 v[128:143], v[176:179], v[32:35], v[16:31]
L_cand162:
    ds_read_b64_tr_b16 v[176:177], v2 offset:2048
    ds_read_b64_tr_b16 v[178:179], v2 offset:3072
    v_exp_f32 v170, v170
    v_exp_f32 v171, v171
    v_mfma_f32_16x16x32_bf16 v[12:15], v[8:11], v[224:227], v[12:15]
    v_cvt_pk_bf16_f32 v228, v168, v169
    v_mfma_f32_32x32x16_bf16 v[128:143], v[240:243], v[36:39], v[128:143]
L_cand163:
    ds_read_b64_tr_b16 v[240:241], v3 offset:2048
    ds_read_b64_tr_b16 v[242:243], v3 offset:3072
    v_exp_f32 v172, v172
    v_exp_f32 v173, v173
    v_mfma_f32_32x32x16_bf16 v[128:143], v[244:247], v[40:43], v[128:143]
L_cand164:
    ds_read_b64_tr_b16 v[244:245], v2 offset:6144
    ds_read_b64_tr_b16 v[246:247], v2 offset:7168
    v_cvt_pk_bf16_f32 v229, v170, v171
    v_exp_f32 v174, v174
    v_mfma_f32_32x32x16_bf16 v[128:143], v[248:251], v[44:47], v[128:143]
L_cand165:
    ds_read_b64_tr_b16 v[248:249], v3 offset:6144
    ds_read_b64_tr_b16 v[250:251], v3 offset:7168
    v_exp_f32 v175, v175
    v_cvt_pk_bf16_f32 v230, v172, v173
    s_waitcnt lgkmcnt(15)
    v_mfma_f32_32x32x16_bf16 v[128:143], v[252:255], v[48:51], v[128:143]
L_cand166:
    ds_read_b128 v[252:255], v4 offset:32768
    v_cvt_pk_bf16_f32 v231, v174, v175
    v_mfma_f32_32x32x16_bf16 v[128:143], v[180:183], v[52:55], v[128:143]
L_cand167:
    ds_read_b128 v[180:183], v5 offset:32768
    v_mfma_f32_16x16x32_bf16 v[12:15], v[8:11], v[228:231], v[12:15]
    v_mfma_f32_32x32x16_bf16 v[128:143], v[184:187], v[56:59], v[128:143]
L_cand168:
    ds_read_b128 v[184:187], v6 offset:32768
    v_mfma_f32_32x32x16_bf16 v[128:143], v[188:191], v[60:63], v[128:143]
L_cand169:
    ds_read_b128 v[188:191], v7 offset:32768
    s_waitcnt lgkmcnt(12)
    v_mfma_f32_32x32x16_bf16 v[64:79], v[192:195], v[208:211], v[64:79]
L_cand170:
    s_barrier
    ds_read_b128 v[192:195], v4 offset:36864
    v_mfma_f32_32x32x16_bf16 v[80:95], v[196:199], v[208:211], v[80:95]
L_cand171:
    ds_read_b128 v[196:199], v5 offset:36864
    s_nop 4
    v_exp_f32 v128, v128
    v_exp_f32 v129, v129
    v_mfma_f32_32x32x16_bf16 v[96:111], v[200:203], v[208:211], v[96:111]
L_cand172:
    ds_read_b128 v[200:203], v6 offset:36864
    v_exp_f32 v130, v130
    v_exp_f32 v131, v131
    v_mfma_f32_32x32x16_bf16 v[112:127], v[204:207], v[208:211], v[112:127]
L_cand173:
    ds_read_b128 v[204:207], v7 offset:36864
    v_cvt_pk_bf16_f32 v232, v128, v129
    v_exp_f32 v132, v132
    s_waitcnt lgkmcnt(8)
    v_mfma_f32_32x32x16_bf16 v[64:79], v[176:179], v[212:215], v[64:79]
L_cand174:
    ds_read_b64_tr_b16 v[176:177], v2 offset:8192
    ds_read_b64_tr_b16 v[178:179], v2 offset:9216
    v_exp_f32 v133, v133
    v_cvt_pk_bf16_f32 v233, v130, v131
    v_mfma_f32_32x32x16_bf16 v[80:95], v[240:243], v[212:215], v[80:95]
L_cand175:
    ds_read_b64_tr_b16 v[240:241], v3 offset:8192
    ds_read_b64_tr_b16 v[242:243], v3 offset:9216
    v_exp_f32 v134, v134
    v_exp_f32 v135, v135
    v_mfma_f32_32x32x16_bf16 v[96:111], v[244:247], v[212:215], v[96:111]
L_cand176:
    ds_read_b64_tr_b16 v[244:245], v2 offset:12288
    ds_read_b64_tr_b16 v[246:247], v2 offset:13312
    v_cvt_pk_bf16_f32 v234, v132, v133
    v_exp_f32 v136, v136
    v_mfma_f32_32x32x16_bf16 v[112:127], v[248:251], v[212:215], v[112:127]
L_cand177:
    ds_read_b64_tr_b16 v[248:249], v3 offset:12288
    ds_read_b64_tr_b16 v[250:251], v3 offset:13312
    v_exp_f32 v137, v137
    v_cvt_pk_bf16_f32 v235, v134, v135
    s_waitcnt lgkmcnt(12)
    v_mfma_f32_32x32x16_bf16 v[144:159], v[252:255], v[32:35], v[16:31]
L_cand178:
    ds_read_b64_tr_b16 v[252:253], v2 offset:10240
    ds_read_b64_tr_b16 v[254:255], v2 offset:11264
    v_exp_f32 v138, v138
    v_exp_f32 v139, v139
    v_mfma_f32_16x16x32_bf16 v[12:15], v[8:11], v[232:235], v[12:15]
    v_cvt_pk_bf16_f32 v236, v136, v137
    v_mfma_f32_32x32x16_bf16 v[144:159], v[180:183], v[36:39], v[144:159]
L_cand179:
    ds_read_b64_tr_b16 v[180:181], v3 offset:10240
    ds_read_b64_tr_b16 v[182:183], v3 offset:11264
    v_exp_f32 v140, v140
    v_exp_f32 v141, v141
    v_mfma_f32_32x32x16_bf16 v[144:159], v[184:187], v[40:43], v[144:159]
L_cand180:
    ds_read_b64_tr_b16 v[184:185], v2 offset:14336
    ds_read_b64_tr_b16 v[186:187], v2 offset:15360
    v_cvt_pk_bf16_f32 v237, v138, v139
    v_exp_f32 v142, v142
    v_mfma_f32_32x32x16_bf16 v[144:159], v[188:191], v[44:47], v[144:159]
L_cand181:
    ds_read_b64_tr_b16 v[188:189], v3 offset:14336
    ds_read_b64_tr_b16 v[190:191], v3 offset:15360
    v_exp_f32 v143, v143
    v_cvt_pk_bf16_f32 v238, v140, v141
    s_waitcnt lgkmcnt(15)
    v_mfma_f32_32x32x16_bf16 v[144:159], v[192:195], v[48:51], v[144:159]
L_pad182:
    s_cbranch_execz L_lback
    ds_read_b128 v[192:195], v4 offset:40960
    v_cvt_pk_bf16_f32 v239, v142, v143
    v_mfma_f32_32x32x16_bf16 v[144:159], v[196:199], v[52:55], v[144:159]
L_cand183:
    ds_read_b128 v[196:199], v5 offset:40960
    v_mfma_f32_16x16x32_bf16 v[12:15], v[8:11], v[236:239], v[12:15]
    v_mfma_f32_32x32x16_bf16 v[144:159], v[200:203], v[56:59], v[144:159]
L_cand184:
    ds_read_b128 v[200:203], v6 offset:40960
    v_mfma_f32_32x32x16_bf16 v[144:159], v[204:207], v[60:63], v[144:159]
L_cand185:
    ds_read_b128 v[204:207], v7 offset:40960
    s_waitcnt lgkmcnt(12)
    v_mfma_f32_32x32x16_bf16 v[64:79], v[176:179], v[216:219], v[64:79]
L_cand186:
    s_barrier
    ds_read_b128 v[176:179], v4 offset:45056
    v_mfma_f32_32x32x16_bf16 v[80:95], v[240:243], v[216:219], v[80:95]
L_cand187:
    ds_read_b128 v[240:243], v5 offset:45056
    s_nop 4
    v_exp_f32 v144, v144
    v_exp_f32 v145, v145
    v_mfma_f32_32x32x16_bf16 v[96:111], v[244:247], v[216:219], v[96:111]
L_cand188:
    ds_read_b128 v[244:247], v6 offset:45056
    v_exp_f32 v146, v146
    v_exp_f32 v147, v147
    v_mfma_f32_32x32x16_bf16 v[112:127], v[248:251], v[216:219], v[112:127]
L_cand189:
    ds_read_b128 v[248:251], v7 offset:45056
    v_cvt_pk_bf16_f32 v208, v144, v145
    v_exp_f32 v148, v148
    s_waitcnt lgkmcnt(8)
    v_mfma_f32_32x32x16_bf16 v[64:79], v[252:255], v[220:223], v[64:79]
L_cand190:
    ds_read_b64_tr_b16 v[252:253], v2 offset:16384
    ds_read_b64_tr_b16 v[254:255], v2 offset:17408
    v_exp_f32 v149, v149
    v_cvt_pk_bf16_f32 v209, v146, v147
    v_mfma_f32_32x32x16_bf16 v[80:95], v[180:183], v[220:223], v[80:95]
L_cand191:
    ds_read_b64_tr_b16 v[180:181], v3 offset:16384
    ds_read_b64_tr_b16 v[182:183], v3 offset:17408
    v_exp_f32 v150, v150
    v_exp_f32 v151, v151
    v_mfma_f32_32x32x16_bf16 v[96:111], v[184:187], v[220:223], v[96:111]
L_cand192:
    ds_read_b64_tr_b16 v[184:185], v2 offset:20480
    ds_read_b64_tr_b16 v[186:187], v2 offset:21504
    v_cvt_pk_bf16_f32 v210, v148, v149
    v_exp_f32 v152, v152
    v_mfma_f32_32x32x16_bf16 v[112:127], v[188:191], v[220:223], v[112:127]
L_cand193:
    ds_read_b64_tr_b16 v[188:189], v3 offset:20480
    ds_read_b64_tr_b16 v[190:191], v3 offset:21504
    v_exp_f32 v153, v153
    v_cvt_pk_bf16_f32 v211, v150, v151
    s_waitcnt lgkmcnt(12)
    v_mfma_f32_32x32x16_bf16 v[160:175], v[192:195], v[32:35], v[16:31]
L_cand194:
    ds_read_b64_tr_b16 v[192:193], v2 offset:18432
    ds_read_b64_tr_b16 v[194:195], v2 offset:19456
    v_exp_f32 v154, v154
    v_exp_f32 v155, v155
    v_mfma_f32_16x16x32_bf16 v[12:15], v[8:11], v[208:211], v[12:15]
    v_cvt_pk_bf16_f32 v212, v152, v153
    v_mfma_f32_32x32x16_bf16 v[160:175], v[196:199], v[36:39], v[160:175]
L_cand195:
    ds_read_b64_tr_b16 v[196:197], v3 offset:18432
    ds_read_b64_tr_b16 v[198:199], v3 offset:19456
    v_exp_f32 v156, v156
    v_exp_f32 v157, v157
    v_mfma_f32_32x32x16_bf16 v[160:175], v[200:203], v[40:43], v[160:175]
L_cand196:
    ds_read_b64_tr_b16 v[200:201], v2 offset:22528
    ds_read_b64_tr_b16 v[202:203], v2 offset:23552
    v_cvt_pk_bf16_f32 v213, v154, v155
    v_exp_f32 v158, v158
    v_mfma_f32_32x32x16_bf16 v[160:175], v[204:207], v[44:47], v[160:175]
L_cand197:
    ds_read_b64_tr_b16 v[204:205], v3 offset:22528
    ds_read_b64_tr_b16 v[206:207], v3 offset:23552
    v_exp_f32 v159, v159
    v_cvt_pk_bf16_f32 v214, v156, v157
    s_waitcnt lgkmcnt(15)
    v_mfma_f32_32x32x16_bf16 v[160:175], v[176:179], v[48:51], v[160:175]
L_cand198:
    ds_read_b128 v[176:179], v4 offset:49152
    v_cvt_pk_bf16_f32 v215, v158, v159
    v_mfma_f32_32x32x16_bf16 v[160:175], v[240:243], v[52:55], v[160:175]
L_cand199:
    ds_read_b128 v[240:243], v5 offset:49152
    v_mfma_f32_16x16x32_bf16 v[12:15], v[8:11], v[212:215], v[12:15]
    v_mfma_f32_32x32x16_bf16 v[160:175], v[244:247], v[56:59], v[160:175]
L_cand200:
    ds_read_b128 v[244:247], v6 offset:49152
    v_mfma_f32_32x32x16_bf16 v[160:175], v[248:251], v[60:63], v[160:175]
L_cand201:
    ds_read_b128 v[248:251], v7 offset:49152
    s_waitcnt lgkmcnt(12)
    v_mfma_f32_32x32x16_bf16 v[64:79], v[252:255], v[224:227], v[64:79]
L_cand202:
    s_barrier
    ds_read_b128 v[252:255], v4 offset:53248
    v_mfma_f32_32x32x16_bf16 v[80:95], v[180:183], v[224:227], v[80:95]
L_cand203:
    ds_read_b128 v[180:183], v5 offset:53248
    s_nop 4
    v_exp_f32 v160, v160
    v_exp_f32 v161, v161
    v_mfma_f32_32x32x16_bf16 v[96:111], v[184:187], v[224:227], v[96:111]
L_cand204:
    ds_read_b128 v[184:187], v6 offset:53248
    v_exp_f32 v162, v162
    v_exp_f32 v163, v163
    v_mfma_f32_32x32x16_bf16 v[112:127], v[188:191], v[224:227], v[112:127]
L_cand205:
    ds_read_b128 v[188:191], v7 offset:53248
    v_cvt_pk_bf16_f32 v216, v160, v161
    v_exp_f32 v164, v164
    s_waitcnt lgkmcnt(8)
    v_mfma_f32_32x32x16_bf16 v[64:79], v[192:195], v[228:231], v[64:79]
L_cand206:
    ds_read_b128 v[192:195], v4 offset:57344
    v_exp_f32 v165, v165
    v_cvt_pk_bf16_f32 v217, v162, v163
    v_mfma_f32_32x32x16_bf16 v[80:95], v[196:199], v[228:231], v[80:95]
L_cand207:
    ds_read_b128 v[196:199], v5 offset:57344
    v_exp_f32 v166, v166
    v_exp_f32 v167, v167
    v_mfma_f32_32x32x16_bf16 v[96:111], v[200:203], v[228:231], v[96:111]
L_cand208:
    ds_read_b128 v[200:203], v6 offset:57344
    v_cvt_pk_bf16_f32 v218, v164, v165
    v_exp_f32 v168, v168
    v_mfma_f32_32x32x16_bf16 v[112:127], v[204:207], v[228:231], v[112:127]
L_cand209:
    ds_read_b128 v[204:207], v7 offset:57344
    v_exp_f32 v169, v169
    v_cvt_pk_bf16_f32 v219, v166, v167
    s_waitcnt lgkmcnt(8)
    v_mfma_f32_32x32x16_bf16 v[128:143], v[176:179], v[32:35], v[16:31]
L_cand210:
    ds_read_b128 v[176:179], v4 offset:61440
    v_exp_f32 v170, v170
    v_exp_f32 v171, v171
    v_mfma_f32_16x16x32_bf16 v[12:15], v[8:11], v[216:219], v[12:15]
    v_cvt_pk_bf16_f32 v220, v168, v169
    v_mfma_f32_32x32x16_bf16 v[128:143], v[240:243], v[36:39], v[128:143]
L_cand211:
    ds_read_b128 v[240:243], v5 offset:61440
    v_exp_f32 v172, v172
    v_exp_f32 v173, v173
    v_mfma_f32_32x32x16_bf16 v[128:143], v[244:247], v[40:43], v[128:143]
L_cand212:
    s_barrier
    ds_read_b128 v[244:247], v6 offset:61440
    v_cvt_pk_bf16_f32 v221, v170, v171
    v_exp_f32 v174, v174
    v_mfma_f32_32x32x16_bf16 v[128:143], v[248:251], v[44:47], v[128:143]
L_cand213:
    ds_read_b128 v[248:251], v7 offset:61440
    v_exp_f32 v175, v175
    v_cvt_pk_bf16_f32 v222, v172, v173
    s_waitcnt lgkmcnt(8)
    v_mfma_f32_32x32x16_bf16 v[128:143], v[252:255], v[48:51], v[128:143]
L_cand214:
    ds_read_b64_tr_b16 v[252:253], v2 offset:24576
    ds_read_b64_tr_b16 v[254:255], v2 offset:25600
    v_cvt_pk_bf16_f32 v223, v174, v175
    v_and_b32 v174, 31, v0
    v_mfma_f32_32x32x16_bf16 v[128:143], v[180:183], v[52:55], v[128:143]
L_cand215:
    ds_read_b64_tr_b16 v[180:181], v2 offset:26624
    ds_read_b64_tr_b16 v[182:183], v2 offset:27648
    v_bfe_u32 v175, v0, 5, 1
    v_and_b32 v167, 7, v0
    v_mfma_f32_16x16x32_bf16 v[12:15], v[8:11], v[220:223], v[12:15]
    v_bfe_u32 v168, v0, 3, 3
    v_mfma_f32_32x32x16_bf16 v[128:143], v[184:187], v[56:59], v[128:143]
L_cand216:
    ds_read_b64_tr_b16 v[184:185], v2 offset:32768
    ds_read_b64_tr_b16 v[186:187], v2 offset:33792
    v_and_b32 v172, 3, v0
    v_mul_u32_u24 v160, 320, v174
    v_mfma_f32_32x32x16_bf16 v[128:143], v[188:191], v[60:63], v[128:143]
L_cand217:
    ds_read_b64_tr_b16 v[188:189], v2 offset:34816
    ds_read_b64_tr_b16 v[190:191], v2 offset:35840
    v_bfe_u32 v171, v174, 2, 2
    v_lshl_or_b32 v160, v171, 4, v160
    s_waitcnt lgkmcnt(12)
    v_mfma_f32_32x32x16_bf16 v[144:159], v[192:195], v[32:35], v[16:31]
L_cand218:
    ds_read_b64_tr_b16 v[192:193], v2 offset:40960
    ds_read_b64_tr_b16 v[194:195], v2 offset:41984
    v_lshl_or_b32 v160, v175, 3, v160
    v_add_u32 v160, s25, v160
    v_mfma_f32_32x32x16_bf16 v[144:159], v[196:199], v[36:39], v[144:159]
L_cand219:
    ds_read_b64_tr_b16 v[196:197], v2 offset:43008
    ds_read_b64_tr_b16 v[198:199], v2 offset:44032
    v_xor_b32 v161, 16, v160
    v_xor_b32 v162, 32, v160
    v_mfma_f32_32x32x16_bf16 v[144:159], v[200:203], v[40:43], v[144:159]
L_cand220:
    ds_read_b64_tr_b16 v[200:201], v2 offset:49152
    ds_read_b64_tr_b16 v[202:203], v2 offset:50176
    v_xor_b32 v163, 48, v160
    v_mul_u32_u24 v164, 320, v168
    v_mfma_f32_32x32x16_bf16 v[144:159], v[204:207], v[44:47], v[144:159]
L_cand221:
    ds_read_b64_tr_b16 v[204:205], v2 offset:51200
    ds_read_b64_tr_b16 v[206:207], v2 offset:52224
    v_lshrrev_b32 v171, 2, v167
    v_lshl_add_u32 v164, v171, 6, v164
    s_waitcnt lgkmcnt(15)
    v_mfma_f32_32x32x16_bf16 v[144:159], v[176:179], v[48:51], v[144:159]
L_cand222:
    ds_read_b64_tr_b16 v[176:177], v2 offset:57344
    ds_read_b64_tr_b16 v[178:179], v2 offset:58368
    v_xor_b32 v172, v172, v175
    v_lshl_or_b32 v164, v172, 4, v164
    v_mfma_f32_32x32x16_bf16 v[144:159], v[240:243], v[52:55], v[144:159]
L_cand223:
    ds_read_b64_tr_b16 v[240:241], v2 offset:59392
    ds_read_b64_tr_b16 v[242:243], v2 offset:60416
    v_add_u32 v164, s25, v164
    v_xor_b32 v165, 32, v164
    v_mfma_f32_32x32x16_bf16 v[144:159], v[244:247], v[56:59], v[144:159]
L_cand224:
    ds_read_b64_tr_b16 v[244:245], v3 offset:24576
    ds_read_b64_tr_b16 v[246:247], v3 offset:25600
    v_exp_f32 v128, v128
    v_exp_f32 v129, v129
    v_mfma_f32_32x32x16_bf16 v[144:159], v[248:251], v[60:63], v[144:159]
L_cand225:
    ds_read_b64_tr_b16 v[248:249], v3 offset:26624
    ds_read_b64_tr_b16 v[250:251], v3 offset:27648
    v_exp_f32 v130, v130
    v_exp_f32 v131, v131
    s_waitcnt lgkmcnt(15)
    v_mfma_f32_32x32x16_bf16 v[64:79], v[252:255], v[232:235], v[64:79]
L_cand226:
    ds_read_b64_tr_b16 v[252:253], v3 offset:32768
    ds_read_b64_tr_b16 v[254:255], v3 offset:33792
    v_cvt_pk_bf16_f32 v224, v128, v129
    v_exp_f32 v132, v132
    v_exp_f32 v133, v133
    v_cvt_pk_bf16_f32 v225, v130, v131
    v_mfma_f32_32x32x16_bf16 v[64:79], v[180:183], v[236:239], v[64:79]
L_cand227:
    ds_read_b64_tr_b16 v[180:181], v3 offset:34816
    ds_read_b64_tr_b16 v[182:183], v3 offset:35840
    v_exp_f32 v134, v134
    v_exp_f32 v135, v135
    v_cvt_pk_bf16_f32 v226, v132, v133
    v_exp_f32 v136, v136
    v_mfma_f32_32x32x16_bf16 v[64:79], v[184:187], v[208:211], v[64:79]
L_cand228:
    ds_read_b64_tr_b16 v[184:185], v3 offset:40960
    ds_read_b64_tr_b16 v[186:187], v3 offset:41984
    v_exp_f32 v137, v137
    v_cvt_pk_bf16_f32 v227, v134, v135
    v_exp_f32 v138, v138
    v_exp_f32 v139, v139
    v_mfma_f32_16x16x32_bf16 v[12:15], v[8:11], v[224:227], v[12:15]
    v_cvt_pk_bf16_f32 v228, v136, v137
    v_mfma_f32_32x32x16_bf16 v[64:79], v[188:191], v[212:215], v[64:79]
L_cand229:
    ds_read_b64_tr_b16 v[188:189], v3 offset:43008
    ds_read_b64_tr_b16 v[190:191], v3 offset:44032
    v_exp_f32 v140, v140
    v_exp_f32 v141, v141
    v_cvt_pk_bf16_f32 v229, v138, v139
    v_exp_f32 v142, v142
    s_waitcnt lgkmcnt(15)
    v_mfma_f32_32x32x16_bf16 v[64:79], v[192:195], v[216:219], v[64:79]
L_cand230:
    ds_read_b64_tr_b16 v[192:193], v3 offset:49152
    ds_read_b64_tr_b16 v[194:195], v3 offset:50176
    v_exp_f32 v143, v143
    v_cvt_pk_bf16_f32 v230, v140, v141
    v_cvt_pk_bf16_f32 v231, v142, v143
    v_exp_f32 v144, v144
    v_mfma_f32_32x32x16_bf16 v[64:79], v[196:199], v[220:223], v[64:79]
L_cand231:
    ds_read_b64_tr_b16 v[196:197], v3 offset:51200
    ds_read_b64_tr_b16 v[198:199], v3 offset:52224
    v_exp_f32 v145, v145
    v_exp_f32 v146, v146
    v_exp_f32 v147, v147
    v_cvt_pk_bf16_f32 v144, v144, v145
    v_mfma_f32_16x16x32_bf16 v[12:15], v[8:11], v[228:231], v[12:15]
    v_exp_f32 v148, v148
    v_mfma_f32_32x32x16_bf16 v[64:79], v[200:203], v[224:227], v[64:79]
L_cand232:
    ds_read_b64_tr_b16 v[200:201], v3 offset:57344
    ds_read_b64_tr_b16 v[202:203], v3 offset:58368
    v_exp_f32 v149, v149
    v_cvt_pk_bf16_f32 v145, v146, v147
    v_exp_f32 v150, v150
    v_exp_f32 v151, v151
    v_mfma_f32_32x32x16_bf16 v[64:79], v[204:207], v[228:231], v[64:79]
L_cand233:
    ds_read_b64_tr_b16 v[204:205], v3 offset:59392
    ds_read_b64_tr_b16 v[206:207], v3 offset:60416
    v_cvt_pk_bf16_f32 v146, v148, v149
    v_exp_f32 v152, v152
    v_exp_f32 v153, v153
    v_cvt_pk_bf16_f32 v147, v150, v151
    s_waitcnt lgkmcnt(15)
    s_nop 0
    v_mfma_f32_32x32x16_bf16 v[64:79], v[176:179], v[144:147], v[64:79]
L_cand234:
    ds_read_b64_tr_b16 v[176:177], v2 offset:28672
    ds_read_b64_tr_b16 v[178:179], v2 offset:29696
    v_exp_f32 v154, v154
    v_exp_f32 v155, v155
    v_cvt_pk_bf16_f32 v148, v152, v153
    v_exp_f32 v156, v156
    v_mfma_f32_16x16x32_bf16 v[12:15], v[8:11], v[144:147], v[12:15]
    v_exp_f32 v157, v157
    v_cvt_pk_bf16_f32 v149, v154, v155
    v_exp_f32 v158, v158
    v_exp_f32 v159, v159
    v_cvt_pk_bf16_f32 v150, v156, v157
    v_cvt_pk_bf16_f32 v151, v158, v159
    s_nop 1
    v_mfma_f32_32x32x16_bf16 v[64:79], v[240:243], v[148:151], v[64:79]
L_cand235:
    ds_read_b64_tr_b16 v[240:241], v2 offset:30720
    ds_read_b64_tr_b16 v[242:243], v2 offset:31744
    v_mfma_f32_32x32x16_bf16 v[80:95], v[244:247], v[232:235], v[80:95]
L_cand236:
    ds_read_b64_tr_b16 v[244:245], v2 offset:36864
    ds_read_b64_tr_b16 v[246:247], v2 offset:37888
    v_mfma_f32_16x16x32_bf16 v[12:15], v[8:11], v[148:151], v[12:15]
    v_mfma_f32_32x32x16_bf16 v[80:95], v[248:251], v[236:239], v[80:95]
L_cand237:
    ds_read_b64_tr_b16 v[248:249], v2 offset:38912
    ds_read_b64_tr_b16 v[250:251], v2 offset:39936
    s_nop 7
    s_nop 0
    v_rcp_f32 v14, v12
    v_cmp_nge_f32 s[36:37], v12, s42
    v_cmp_nle_f32 s[38:39], v12, s43
    v_mul_f32 v64, v14, v64
    s_waitcnt lgkmcnt(15)
    v_mfma_f32_32x32x16_bf16 v[80:95], v[252:255], v[208:211], v[80:95]
L_cand238:
    ds_read_b64_tr_b16 v[252:253], v2 offset:45056
    ds_read_b64_tr_b16 v[254:255], v2 offset:46080
    v_mul_f32 v65, v14, v65
    v_mul_f32 v66, v14, v66
    v_mul_f32 v67, v14, v67
    v_mul_f32 v68, v14, v68
    v_mfma_f32_32x32x16_bf16 v[80:95], v[180:183], v[212:215], v[80:95]
L_cand239:
    ds_read_b64_tr_b16 v[180:181], v2 offset:47104
    ds_read_b64_tr_b16 v[182:183], v2 offset:48128
    v_mul_f32 v69, v14, v69
    v_mul_f32 v70, v14, v70
    v_mul_f32 v71, v14, v71
    v_cvt_pk_bf16_f32 v64, v64, v65
    v_mfma_f32_32x32x16_bf16 v[80:95], v[184:187], v[216:219], v[80:95]
L_cand240:
    ds_read_b64_tr_b16 v[184:185], v2 offset:53248
    ds_read_b64_tr_b16 v[186:187], v2 offset:54272
    v_cvt_pk_bf16_f32 v65, v66, v67
    v_mul_f32 v72, v14, v72
    v_mul_f32 v73, v14, v73
    v_mul_f32 v74, v14, v74
    v_mfma_f32_32x32x16_bf16 v[80:95], v[188:191], v[220:223], v[80:95]
L_cand241:
    ds_read_b64_tr_b16 v[188:189], v2 offset:55296
    ds_read_b64_tr_b16 v[190:191], v2 offset:56320
    v_mul_f32 v75, v14, v75
    v_cvt_pk_bf16_f32 v66, v68, v69
    v_cvt_pk_bf16_f32 v67, v70, v71
    ds_write_b64 v160, v[64:65] offset:0
    s_waitcnt lgkmcnt(15)
    v_mfma_f32_32x32x16_bf16 v[80:95], v[192:195], v[224:227], v[80:95]
L_cand242:
    ds_read_b64_tr_b16 v[192:193], v2 offset:61440
    ds_read_b64_tr_b16 v[194:195], v2 offset:62464
    v_mul_f32 v76, v14, v76
    v_mul_f32 v77, v14, v77
    v_mul_f32 v78, v14, v78
    v_mul_f32 v79, v14, v79
    v_mfma_f32_32x32x16_bf16 v[80:95], v[196:199], v[228:231], v[80:95]
L_cand243:
    ds_read_b64_tr_b16 v[196:197], v2 offset:63488
    ds_read_b64_tr_b16 v[198:199], v2 offset:64512
    v_cvt_pk_bf16_f32 v68, v72, v73
    v_cvt_pk_bf16_f32 v69, v74, v75
    ds_write_b64 v161, v[66:67] offset:0
    v_cvt_pk_bf16_f32 v70, v76, v77
    v_mfma_f32_32x32x16_bf16 v[80:95], v[200:203], v[144:147], v[80:95]
L_cand244:
    ds_read_b64_tr_b16 v[200:201], v3 offset:28672
    ds_read_b64_tr_b16 v[202:203], v3 offset:29696
    v_cvt_pk_bf16_f32 v71, v78, v79
    ds_write_b64 v162, v[68:69] offset:0
    ds_write_b64 v163, v[70:71] offset:0
    v_mfma_f32_32x32x16_bf16 v[80:95], v[204:207], v[148:151], v[80:95]
L_cand245:
    ds_read_b64_tr_b16 v[204:205], v3 offset:30720
    ds_read_b64_tr_b16 v[206:207], v3 offset:31744
    s_waitcnt lgkmcnt(15)
    v_mfma_f32_32x32x16_bf16 v[96:111], v[176:179], v[232:235], v[96:111]
L_cand246:
    ds_read_b64_tr_b16 v[176:177], v3 offset:36864
    ds_read_b64_tr_b16 v[178:179], v3 offset:37888
    v_mfma_f32_32x32x16_bf16 v[96:111], v[240:243], v[236:239], v[96:111]
L_cand247:
    ds_read_b64_tr_b16 v[240:241], v3 offset:38912
    ds_read_b64_tr_b16 v[242:243], v3 offset:39936
    s_nop 2
    v_mul_f32 v80, v14, v80
    v_mul_f32 v81, v14, v81
    v_mul_f32 v82, v14, v82
    v_mul_f32 v83, v14, v83
    v_mfma_f32_32x32x16_bf16 v[96:111], v[244:247], v[208:211], v[96:111]
L_cand248:
    ds_read_b64_tr_b16 v[244:245], v3 offset:45056
    ds_read_b64_tr_b16 v[246:247], v3 offset:46080
    v_mul_f32 v84, v14, v84
    v_mul_f32 v85, v14, v85
    v_mul_f32 v86, v14, v86
    v_mul_f32 v87, v14, v87
    v_mfma_f32_32x32x16_bf16 v[96:111], v[248:251], v[212:215], v[96:111]
L_cand249:
    ds_read_b64_tr_b16 v[248:249], v3 offset:47104
    ds_read_b64_tr_b16 v[250:251], v3 offset:48128
    v_cvt_pk_bf16_f32 v80, v80, v81
    v_cvt_pk_bf16_f32 v81, v82, v83
    v_mul_f32 v88, v14, v88
    v_mul_f32 v89, v14, v89
    v_mfma_f32_32x32x16_bf16 v[96:111], v[252:255], v[216:219], v[96:111]
L_cand250:
    ds_read_b64_tr_b16 v[252:253], v3 offset:53248
    ds_read_b64_tr_b16 v[254:255], v3 offset:54272
    v_mul_f32 v90, v14, v90
    v_mul_f32 v91, v14, v91
    v_cvt_pk_bf16_f32 v82, v84, v85
    v_cvt_pk_bf16_f32 v83, v86, v87
    v_mfma_f32_32x32x16_bf16 v[96:111], v[180:183], v[220:223], v[96:111]
L_cand251:
    ds_read_b64_tr_b16 v[180:181], v3 offset:55296
    ds_read_b64_tr_b16 v[182:183], v3 offset:56320
    ds_write_b64 v160, v[80:81] offset:64
    v_mul_f32 v92, v14, v92
    v_mul_f32 v93, v14, v93
    v_mul_f32 v94, v14, v94
    s_waitcnt lgkmcnt(15)
    v_mfma_f32_32x32x16_bf16 v[96:111], v[184:187], v[224:227], v[96:111]
L_cand252:
    ds_read_b64_tr_b16 v[184:185], v3 offset:61440
    ds_read_b64_tr_b16 v[186:187], v3 offset:62464
    v_mul_f32 v95, v14, v95
    v_cvt_pk_bf16_f32 v84, v88, v89
    v_cvt_pk_bf16_f32 v85, v90, v91
    ds_write_b64 v161, v[82:83] offset:64
    v_mfma_f32_32x32x16_bf16 v[96:111], v[188:191], v[228:231], v[96:111]
L_cand253:
    ds_read_b64_tr_b16 v[188:189], v3 offset:63488
    ds_read_b64_tr_b16 v[190:191], v3 offset:64512
    v_cvt_pk_bf16_f32 v86, v92, v93
    v_cvt_pk_bf16_f32 v87, v94, v95
    ds_write_b64 v162, v[84:85] offset:64
    ds_write_b64 v163, v[86:87] offset:64
    v_mfma_f32_32x32x16_bf16 v[96:111], v[192:195], v[144:147], v[96:111]
L_cand254:
    ds_read_b128 v[64:67], v164 offset:0
    ds_read_b128 v[68:71], v165 offset:2560
    ds_read_b128 v[72:75], v164 offset:5120
    ds_read_b128 v[76:79], v165 offset:7680
    v_mfma_f32_32x32x16_bf16 v[96:111], v[196:199], v[148:151], v[96:111]
L_cand255:
    s_waitcnt lgkmcnt(3)
    buffer_store_dwordx4 v[64:67], v1, s[20:23], s35 offen offset:0 sc1 nt
    s_waitcnt lgkmcnt(2)
    buffer_store_dwordx4 v[68:71], v1, s[20:23], s35 offen offset:2048 sc1 nt
    s_waitcnt lgkmcnt(1)
    buffer_store_dwordx4 v[72:75], v1, s[20:23], s34 offen offset:0 sc1 nt
    s_waitcnt lgkmcnt(0)
    buffer_store_dwordx4 v[76:79], v1, s[20:23], s34 offen offset:2048 sc1 nt
    v_mfma_f32_32x32x16_bf16 v[112:127], v[200:203], v[232:235], v[112:127]
L_cand256:
    v_mfma_f32_32x32x16_bf16 v[112:127], v[204:207], v[236:239], v[112:127]
L_cand257:
    s_nop 1
    v_mul_f32 v96, v14, v96
    v_mul_f32 v97, v14, v97
    v_mul_f32 v98, v14, v98
    v_mul_f32 v99, v14, v99
    v_mfma_f32_32x32x16_bf16 v[112:127], v[176:179], v[208:211], v[112:127]
L_cand258:
    v_mul_f32 v100, v14, v100
    v_mul_f32 v101, v14, v101
    v_mul_f32 v102, v14, v102
    v_mul_f32 v103, v14, v103
    v_mfma_f32_32x32x16_bf16 v[112:127], v[240:243], v[212:215], v[112:127]
L_cand259:
    v_cvt_pk_bf16_f32 v96, v96, v97
    v_cvt_pk_bf16_f32 v97, v98, v99
    v_mul_f32 v104, v14, v104
    v_mul_f32 v105, v14, v105
    v_mfma_f32_32x32x16_bf16 v[112:127], v[244:247], v[216:219], v[112:127]
L_cand260:
    v_mul_f32 v106, v14, v106
    v_mul_f32 v107, v14, v107
    v_cvt_pk_bf16_f32 v98, v100, v101
    v_cvt_pk_bf16_f32 v99, v102, v103
    v_mfma_f32_32x32x16_bf16 v[112:127], v[248:251], v[220:223], v[112:127]
L_cand261:
    ds_write_b64 v160, v[96:97] offset:128
    v_mul_f32 v108, v14, v108
    v_mul_f32 v109, v14, v109
    v_mul_f32 v110, v14, v110
    v_mfma_f32_32x32x16_bf16 v[112:127], v[252:255], v[224:227], v[112:127]
L_cand262:
    v_mul_f32 v111, v14, v111
    v_cvt_pk_bf16_f32 v100, v104, v105
    v_cvt_pk_bf16_f32 v101, v106, v107
    ds_write_b64 v161, v[98:99] offset:128
    v_mfma_f32_32x32x16_bf16 v[112:127], v[180:183], v[228:231], v[112:127]
L_cand263:
    v_cvt_pk_bf16_f32 v102, v108, v109
    v_cvt_pk_bf16_f32 v103, v110, v111
    ds_write_b64 v162, v[100:101] offset:128
    ds_write_b64 v163, v[102:103] offset:128
    v_mfma_f32_32x32x16_bf16 v[112:127], v[184:187], v[144:147], v[112:127]
L_cand264:
    v_mfma_f32_32x32x16_bf16 v[112:127], v[188:191], v[148:151], v[112:127]
L_cand265:
    s_nop 7
    s_nop 3
    v_pk_mul_f32 v[112:113], v[112:113], v[14:15] op_sel_hi:[1,0]
    v_pk_mul_f32 v[114:115], v[114:115], v[14:15] op_sel_hi:[1,0]
    v_pk_mul_f32 v[116:117], v[116:117], v[14:15] op_sel_hi:[1,0]
    v_pk_mul_f32 v[118:119], v[118:119], v[14:15] op_sel_hi:[1,0]
    v_pk_mul_f32 v[120:121], v[120:121], v[14:15] op_sel_hi:[1,0]
    v_pk_mul_f32 v[122:123], v[122:123], v[14:15] op_sel_hi:[1,0]
    v_pk_mul_f32 v[124:125], v[124:125], v[14:15] op_sel_hi:[1,0]
    v_pk_mul_f32 v[126:127], v[126:127], v[14:15] op_sel_hi:[1,0]
    v_cvt_pk_bf16_f32 v112, v112, v113
    v_cvt_pk_bf16_f32 v113, v114, v115
    v_cvt_pk_bf16_f32 v114, v116, v117
    v_cvt_pk_bf16_f32 v115, v118, v119
L_cand266:
    v_cvt_pk_bf16_f32 v116, v120, v121
    v_cvt_pk_bf16_f32 v117, v122, v123
    v_cvt_pk_bf16_f32 v118, v124, v125
    v_cvt_pk_bf16_f32 v119, v126, v127
    ds_write_b64 v160, v[112:113] offset:192
    ds_write_b64 v161, v[114:115] offset:192
    ds_write_b64 v162, v[116:117] offset:192
    ds_write_b64 v163, v[118:119] offset:192
    ds_read_b128 v[80:83], v164 offset:128
    ds_read_b128 v[84:87], v165 offset:2688
    ds_read_b128 v[88:91], v164 offset:5248
    ds_read_b128 v[92:95], v165 offset:7808
L_cand267:
    s_waitcnt lgkmcnt(3)
    buffer_store_dwordx4 v[80:83], v1, s[20:23], s35 offen offset:128 sc1 nt
    s_waitcnt lgkmcnt(2)
    buffer_store_dwordx4 v[84:87], v1, s[20:23], s35 offen offset:2176 sc1 nt
    s_waitcnt lgkmcnt(1)
    buffer_store_dwordx4 v[88:91], v1, s[20:23], s34 offen offset:128 sc1 nt
    s_waitcnt lgkmcnt(0)
    buffer_store_dwordx4 v[92:95], v1, s[20:23], s34 offen offset:2176 sc1 nt
L_cand268:
    s_cmp_lg_u32 s30, 0
    s_cbranch_scc1 L_end
    s_or_b64 s[36:37], s[36:37], s[38:39]
    v_mov_b32 v2, 133120
    s_cbranch_scc0 L_ok
    v_mov_b32 v3, 1
    ds_write_b32 v2, v3
    s_waitcnt lgkmcnt(0)
L_ok:
    s_barrier
    ds_read_b32 v3, v2
    s_waitcnt lgkmcnt(0)
    v_readfirstlane_b32 s36, v3
    s_nop 3
    s_cmp_lg_u32 s36, 0
    s_cbranch_scc1 L_fb
L_end:
    s_endpgm
L_fb:
    s_waitcnt vmcnt(0)
    v_mov_b32 v13, 0xff800000
    v_and_b32 v2, 31, v0
    v_bfe_u32 v3, v0, 5, 1
    v_lshlrev_b32 v12, 8, v2
    v_lshl_or_b32 v12, v3, 4, v12
    s_mov_b32 s31, s29
    s_add_u32 s36, s29, 0x20000
L_max:
    buffer_load_dwordx4 v[176:179], v12, s[12:15], s31 offen offset:0
    buffer_load_dwordx4 v[180:183], v12, s[12:15], s31 offen offset:32
    buffer_load_dwordx4 v[184:187], v12, s[12:15], s31 offen offset:64
    buffer_load_dwordx4 v[188:191], v12, s[12:15], s31 offen offset:96
    buffer_load_dwordx4 v[192:195], v12, s[12:15], s31 offen offset:128
    buffer_load_dwordx4 v[196:199], v12, s[12:15], s31 offen offset:160
    buffer_load_dwordx4 v[200:203], v12, s[12:15], s31 offen offset:192
    buffer_load_dwordx4 v[204:207], v12, s[12:15], s31 offen offset:224
    s_waitcnt vmcnt(0)
    v_mfma_f32_32x32x16_bf16 v[128:143], v[176:179], v[32:35], 0
    v_mfma_f32_32x32x16_bf16 v[128:143], v[180:183], v[36:39], v[128:143]
    v_mfma_f32_32x32x16_bf16 v[128:143], v[184:187], v[40:43], v[128:143]
    v_mfma_f32_32x32x16_bf16 v[128:143], v[188:191], v[44:47], v[128:143]
    v_mfma_f32_32x32x16_bf16 v[128:143], v[192:195], v[48:51], v[128:143]
    v_mfma_f32_32x32x16_bf16 v[128:143], v[196:199], v[52:55], v[128:143]
    v_mfma_f32_32x32x16_bf16 v[128:143], v[200:203], v[56:59], v[128:143]
    v_mfma_f32_32x32x16_bf16 v[128:143], v[204:207], v[60:63], v[128:143]
    s_nop 7
    s_nop 7
    v_max3_f32 v13, v13, v128, v129
    v_max3_f32 v13, v13, v130, v131
    v_max3_f32 v13, v13, v132, v133
    v_max3_f32 v13, v13, v134, v135
    v_max3_f32 v13, v13, v136, v137
    v_max3_f32 v13, v13, v138, v139
    v_max3_f32 v13, v13, v140, v141
    v_max3_f32 v13, v13, v142, v143
    s_add_u32 s31, s31, 0x2000
    s_cmp_lt_u32 s31, s36
    s_cbranch_scc1 L_max
    v_mov_b32 v14, v13
    s_nop 1
    v_permlane32_swap_b32 v13, v14
    v_max_f32 v13, v13, v14
    v_sub_f32 v16, 0, v13
    v_sub_f32 v17, 0, v13
    v_sub_f32 v18, 0, v13
    v_sub_f32 v19, 0, v13
    v_sub_f32 v20, 0, v13
    v_sub_f32 v21, 0, v13
    v_sub_f32 v22, 0, v13
    v_sub_f32 v23, 0, v13
    v_sub_f32 v24, 0, v13
    v_sub_f32 v25, 0, v13
    v_sub_f32 v26, 0, v13
    v_sub_f32 v27, 0, v13
    v_sub_f32 v28, 0, v13
    v_sub_f32 v29, 0, v13
    v_sub_f32 v30, 0, v13
    v_sub_f32 v31, 0, v13
    s_mov_b32 s30, 1
    v_bfe_u32 v3, v0, 3, 3
    v_and_b32 v4, 7, v0
    s_branch L_top_c
.section .rodata,"a"
.p2align 6
.amdhsa_kernel standalone__gqa_softmax__near_ridge_kernel
  .amdhsa_next_free_vgpr 256
  .amdhsa_next_free_sgpr 102
  .amdhsa_accum_offset 256
  .amdhsa_group_segment_fixed_size 0
  .amdhsa_kernarg_size 48
  .amdhsa_user_sgpr_count 2
  .amdhsa_user_sgpr_kernarg_segment_ptr 1
  .amdhsa_system_sgpr_workgroup_id_x 1
.end_amdhsa_kernel
```
